```python
import torch

def _softmax(x, axis=-1):
    return torch.softmax(x, dim=axis)
def _gelu(x):
    return torch.nn.functional.gelu(x, approximate="tanh")
def _silu(x):
    return torch.nn.functional.silu(x)
def _sigmoid(x):
    return torch.sigmoid(x)
def _layernorm(x, axis=-1, eps=1e-5):
    m = x.mean(dim=axis, keepdim=True)
    v = x.var(dim=axis, keepdim=True, unbiased=False)
    return (x - m) / torch.sqrt(v + eps)
def _scatter_add(tgt, idx, src, axis=0):
    return tgt.clone().index_add_(axis, idx, src)
def _segment_sum(src, seg, n):
    out = torch.zeros((n,) + src.shape[1:], dtype=src.dtype)
    return out.index_add_(0, seg, src)
def _pad(x, pw):
    flat = tuple(v for pair in reversed(pw) for v in pair)
    return torch.nn.functional.pad(x, flat)

kernel_name = 'parallel_sum__mha_block_cached__geglu_ffn__decode'

def setup_inputs():

    _w = (lambda a: (lambda t: t.to(torch.bfloat16) if t.is_floating_point() else t)(torch.as_tensor(a)))
    def _A_setup():
        B, Sq, D = 1, 1, 576
        H, Sk, Dh = 32, 16384, 128
        return {
            "x": _w((lambda *s: torch.randn(*s, dtype=torch.bfloat16) * 0.05)(B, Sq, D)),
            "k_cache": _w((lambda *s: torch.randn(*s, dtype=torch.bfloat16) * 3.2)(B, H, Sk, Dh)),
            "v_cache": _w((lambda *s: torch.randn(*s, dtype=torch.bfloat16) * 1.6)(B, H, Sk, Dh)),
            "wq": _w((lambda *s: torch.randn(*s, dtype=torch.bfloat16) * 3.2)(D, H * Dh) * (D ** -0.5)),
            "wo": _w((lambda *s: torch.randn(*s, dtype=torch.bfloat16) * 1.6)(H * Dh, D) * ((H * Dh) ** -0.5)),
        }
    _A_in = _A_setup()

    def _B_setup():
        B, S, D, F = 1, 1, 576, 4608
        return {
            "x": _w((lambda *s: torch.randn(*s, dtype=torch.bfloat16) * 0.05)(B, S, D)),
            "w_gate": _w((lambda *s: torch.randn(*s, dtype=torch.bfloat16) * 0.05)(D, F)),
            "w_up": _w((lambda *s: torch.randn(*s, dtype=torch.bfloat16) * 0.05)(D, F)),
            "w_down": _w((lambda *s: torch.randn(*s, dtype=torch.bfloat16) * 0.05)(F, D)),
        }
    _B_in = _B_setup()

    return {
        "A_x": _A_in["x"],
        "A_k_cache": _A_in["k_cache"],
        "A_v_cache": _A_in["v_cache"],
        "A_wq": _A_in["wq"],
        "A_wo": _A_in["wo"],
        "B_x": _B_in["x"],
        "B_w_gate": _B_in["w_gate"],
        "B_w_up": _B_in["w_up"],
        "B_w_down": _B_in["w_down"],
    }

def reference(A_x, A_k_cache, A_v_cache, A_wq, A_wo, B_x, B_w_gate, B_w_up, B_w_down):
    def _A_ref(x, k_cache, v_cache, wq, wo):
        B, Sq, D = x.shape
        H, Dh = 32, 128
        q = (lambda x, *d: x.permute(*d))((x @ wq).reshape(B, Sq, H, Dh), 0, 2, 1, 3)
        scores = torch.einsum("bhqd,bhkd->bhqk", q, k_cache) * (Dh ** -0.5)
        p = _softmax(scores, axis=-1)
        o = torch.einsum("bhqk,bhkd->bhqd", p, v_cache)
        return (lambda x, *d: x.permute(*d))(o, 0, 2, 1, 3).reshape(B, Sq, H * Dh) @ wo

    def _B_ref(x, w_gate, w_up, w_down):
        return (_gelu(x @ w_gate) * (x @ w_up)) @ w_down

    x = A_x
    xn = _layernorm(x, axis=-1)
    return x + _A_ref(xn, A_k_cache, A_v_cache, A_wq, A_wo) + _B_ref(xn, B_w_gate, B_w_up, B_w_down)
```

```asm
; @launch kernel=parallel_sum__mha_block_cached__geglu_ffn__decode_kernel grid=(256,1,1) block=(512,1,1) lds=38912
; @launch kernel=fin_kernel grid=(36,1,1) block=(256,1,1) lds=2048
.amdgcn_target "amdgcn-amd-amdhsa--gfx950"
.text
.globl parallel_sum__mha_block_cached__geglu_ffn__decode_kernel
.p2align 8
.type parallel_sum__mha_block_cached__geglu_ffn__decode_kernel,@function
parallel_sum__mha_block_cached__geglu_ffn__decode_kernel:
    s_cmp_ge_u32 s2, 256
    s_cbranch_scc1 L_exit
    s_load_dwordx16 s[16:31], s[0:1], 0
    s_load_dwordx8 s[32:39], s[0:1], 64
    v_lshrrev_b32 v1, 6, v0
    v_and_b32 v2, 63, v0
    s_nop 0
    v_readfirstlane_b32 s3, v1
    s_and_b32 s4, s2, 7
    s_lshr_b32 s5, s2, 3
    s_mov_b32 s70, 0x3fb8aa3b
    s_mov_b32 s71, 0x3db504f3
    s_waitcnt lgkmcnt(0)
    s_mov_b32 s40, s16
    s_and_b32 s41, s17, 0xffff
    s_movk_i32 s42, 1152
    s_mov_b32 s43, 0x00020000
    s_mov_b32 s64, s38
    s_and_b32 s65, s39, 0xffff
    s_mov_b32 s66, 0x200000
    s_mov_b32 s67, 0x00020000
    v_lshlrev_b32 v1, 4, v2
    v_lshlrev_b32 v3, 1, v2
    buffer_load_dwordx4 v[16:19], v1, s[40:43], 0 offen
    buffer_load_ushort v20, v3, s[40:43], 0 offen offset:1024
    s_cmp_ge_u32 s5, 28
    s_cbranch_scc1 L_ffn
    s_mul_i32 s6, s5, 37
    s_lshr_b32 s6, s6, 8
    s_mul_i32 s7, s6, 7
    s_sub_u32 s7, s5, s7
    s_lshl_b32 s8, s4, 2
    s_add_u32 s8, s8, s6
    s_mov_b32 s52, s22
    s_and_b32 s53, s23, 0xffff
    s_mov_b32 s54, 4718592
    s_mov_b32 s55, 0x00020000
    s_mov_b32 s56, s24
    s_and_b32 s57, s25, 0xffff
    s_add_u32 s58, s8, 1
    s_mul_i32 s58, s58, 147456
    s_mov_b32 s59, 0x00020000
    s_cmp_lt_u32 s7, 2
    s_cselect_b32 s12, 19, 18
    s_lshl_b32 s13, s7, 15
    s_lshl_b32 s9, s3, 12
    s_add_u32 s13, s13, s9
    s_movk_i32 s11, 1024
    s_lshl_b32 s14, s8, 22
    s_add_u32 s44, s18, s14
    s_addc_u32 s45, s19, 0
    s_and_b32 s45, s45, 0xffff
    s_lshl_b32 s46, s11, 12
    s_mov_b32 s47, 0x00020000
    s_add_u32 s48, s20, s14
    s_addc_u32 s49, s21, 0
    s_and_b32 s49, s49, 0xffff
    s_mov_b32 s50, s46
    s_mov_b32 s51, 0x00020000
    v_lshrrev_b32 v36, 4, v0
    v_lshlrev_b32 v37, 13, v36
    v_and_b32 v38, 15, v0
    v_lshl_add_u32 v37, v38, 4, v37
    s_lshl_b32 s15, s8, 8
    buffer_load_dwordx4 v[40:43], v37, s[52:55], s15 offen
    s_add_u32 s15, s15, 262144
    buffer_load_dwordx4 v[44:47], v37, s[52:55], s15 offen
    s_add_u32 s15, s15, 262144
    buffer_load_dwordx4 v[48:51], v37, s[52:55], s15 offen
    s_add_u32 s15, s15, 262144
    buffer_load_dwordx4 v[52:55], v37, s[52:55], s15 offen
    s_add_u32 s15, s15, 262144
    buffer_load_dwordx4 v[56:59], v37, s[52:55], s15 offen
    s_add_u32 s15, s15, 262144
    buffer_load_dwordx4 v[60:63], v37, s[52:55], s15 offen
    s_add_u32 s15, s15, 262144
    buffer_load_dwordx4 v[64:67], v37, s[52:55], s15 offen
    s_add_u32 s15, s15, 262144
    buffer_load_dwordx4 v[68:71], v37, s[52:55], s15 offen
    s_add_u32 s15, s15, 262144
    buffer_load_dwordx4 v[72:75], v37, s[52:55], s15 offen
    s_add_u32 s15, s15, 262144
    buffer_load_dwordx4 v[76:79], v37, s[52:55], s15 offen
    s_add_u32 s15, s15, 262144
    buffer_load_dwordx4 v[80:83], v37, s[52:55], s15 offen
    s_add_u32 s15, s15, 262144
    buffer_load_dwordx4 v[84:87], v37, s[52:55], s15 offen
    s_add_u32 s15, s15, 262144
    buffer_load_dwordx4 v[88:91], v37, s[52:55], s15 offen
    s_add_u32 s15, s15, 262144
    buffer_load_dwordx4 v[92:95], v37, s[52:55], s15 offen
    s_add_u32 s15, s15, 262144
    buffer_load_dwordx4 v[96:99], v37, s[52:55], s15 offen
    s_add_u32 s15, s15, 262144
    buffer_load_dwordx4 v[100:103], v37, s[52:55], s15 offen
    s_add_u32 s15, s15, 262144
    buffer_load_dwordx4 v[104:107], v37, s[52:55], s15 offen
    s_add_u32 s15, s15, 262144
    buffer_load_dwordx4 v[108:111], v37, s[52:55], s15 offen
    buffer_load_dwordx4 v[116:119], v1, s[44:47], s13 offen offset:0 nt
    buffer_load_dwordx4 v[120:123], v1, s[44:47], s13 offen offset:1024 nt
    buffer_load_dwordx4 v[124:127], v1, s[44:47], s13 offen offset:2048 nt
    buffer_load_dwordx4 v[128:131], v1, s[44:47], s13 offen offset:3072 nt
    buffer_load_dwordx4 v[132:135], v1, s[48:51], s13 offen offset:0 nt
    buffer_load_dwordx4 v[136:139], v1, s[48:51], s13 offen offset:1024 nt
    buffer_load_dwordx4 v[140:143], v1, s[48:51], s13 offen offset:2048 nt
    buffer_load_dwordx4 v[144:147], v1, s[48:51], s13 offen offset:3072 nt
    s_add_u32 s13, s13, 229376
    buffer_load_dwordx4 v[148:151], v1, s[44:47], s13 offen offset:0 nt
    buffer_load_dwordx4 v[152:155], v1, s[44:47], s13 offen offset:1024 nt
    buffer_load_dwordx4 v[156:159], v1, s[44:47], s13 offen offset:2048 nt
    buffer_load_dwordx4 v[160:163], v1, s[44:47], s13 offen offset:3072 nt
    buffer_load_dwordx4 v[164:167], v1, s[48:51], s13 offen offset:0 nt
    buffer_load_dwordx4 v[168:171], v1, s[48:51], s13 offen offset:1024 nt
    buffer_load_dwordx4 v[172:175], v1, s[48:51], s13 offen offset:2048 nt
    buffer_load_dwordx4 v[176:179], v1, s[48:51], s13 offen offset:3072 nt
    s_add_u32 s13, s13, 229376
    s_waitcnt vmcnt(34)
    v_lshlrev_b32 v22, 16, v16
    v_and_b32 v23, 0xffff0000, v16
    v_lshlrev_b32 v24, 16, v17
    v_and_b32 v25, 0xffff0000, v17
    v_lshlrev_b32 v26, 16, v18
    v_and_b32 v27, 0xffff0000, v18
    v_lshlrev_b32 v28, 16, v19
    v_and_b32 v29, 0xffff0000, v19
    v_lshlrev_b32 v30, 16, v20
    v_add_f32 v31, v22, v23
    v_add_f32 v31, v31, v24
    v_add_f32 v31, v31, v25
    v_add_f32 v31, v31, v26
    v_add_f32 v31, v31, v27
    v_add_f32 v31, v31, v28
    v_add_f32 v31, v31, v29
    v_add_f32 v31, v31, v30
    s_nop 1
    v_add_f32_dpp v31, v31, v31 row_ror:8 row_mask:0xf bank_mask:0xf
    s_nop 1
    v_add_f32_dpp v31, v31, v31 row_ror:4 row_mask:0xf bank_mask:0xf
    s_nop 1
    v_add_f32_dpp v31, v31, v31 row_ror:2 row_mask:0xf bank_mask:0xf
    s_nop 1
    v_add_f32_dpp v31, v31, v31 row_ror:1 row_mask:0xf bank_mask:0xf
    s_nop 1
    v_mov_b32 v32, v31
    s_nop 1
    v_permlane16_swap_b32 v31, v32
    s_nop 1
    v_add_f32 v31, v31, v32
    v_mov_b32 v32, v31
    s_nop 1
    v_permlane32_swap_b32 v31, v32
    s_nop 1
    v_add_f32 v31, v31, v32
    v_mul_f32 v31, 0x3ae38e39, v31
    v_sub_f32 v33, v22, v31
    v_mul_f32 v32, v33, v33
    v_sub_f32 v33, v23, v31
    v_fmac_f32 v32, v33, v33
    v_sub_f32 v33, v24, v31
    v_fmac_f32 v32, v33, v33
    v_sub_f32 v33, v25, v31
    v_fmac_f32 v32, v33, v33
    v_sub_f32 v33, v26, v31
    v_fmac_f32 v32, v33, v33
    v_sub_f32 v33, v27, v31
    v_fmac_f32 v32, v33, v33
    v_sub_f32 v33, v28, v31
    v_fmac_f32 v32, v33, v33
    v_sub_f32 v33, v29, v31
    v_fmac_f32 v32, v33, v33
    v_sub_f32 v33, v30, v31
    v_fmac_f32 v32, v33, v33
    s_nop 1
    v_add_f32_dpp v32, v32, v32 row_ror:8 row_mask:0xf bank_mask:0xf
    s_nop 1
    v_add_f32_dpp v32, v32, v32 row_ror:4 row_mask:0xf bank_mask:0xf
    s_nop 1
    v_add_f32_dpp v32, v32, v32 row_ror:2 row_mask:0xf bank_mask:0xf
    s_nop 1
    v_add_f32_dpp v32, v32, v32 row_ror:1 row_mask:0xf bank_mask:0xf
    s_nop 1
    v_mov_b32 v33, v32
    s_nop 1
    v_permlane16_swap_b32 v32, v33
    s_nop 1
    v_add_f32 v32, v32, v33
    v_mov_b32 v33, v32
    s_nop 1
    v_permlane32_swap_b32 v32, v33
    s_nop 1
    v_add_f32 v32, v32, v33
    v_mul_f32 v32, 0x3ae38e39, v32
    v_cvt_pk_bf16_f32 v32, v32, v32
    v_and_b32 v32, 0xffff0000, v32
    v_add_f32 v32, 0x3727c5ac, v32
    v_cvt_pk_bf16_f32 v32, v32, v32
    v_and_b32 v32, 0xffff0000, v32
    v_sqrt_f32 v32, v32
    s_nop 0
    v_cvt_pk_bf16_f32 v32, v32, v32
    v_and_b32 v32, 0xffff0000, v32
    v_rcp_f32 v33, v32
    v_cvt_pk_bf16_f32 v31, v31, v31
    v_and_b32 v31, 0xffff0000, v31
    v_sub_f32 v22, v22, v31
    v_cvt_pk_bf16_f32 v22, v22, v22
    v_and_b32 v22, 0xffff0000, v22
    v_mul_f32 v34, v22, v33
    v_fma_f32 v35, -v34, v32, v22
    v_fma_f32 v22, v35, v33, v34
    v_cvt_pk_bf16_f32 v22, v22, v22
    v_and_b32 v22, 0xffff0000, v22
    v_sub_f32 v23, v23, v31
    v_cvt_pk_bf16_f32 v23, v23, v23
    v_and_b32 v23, 0xffff0000, v23
    v_mul_f32 v34, v23, v33
    v_fma_f32 v35, -v34, v32, v23
    v_fma_f32 v23, v35, v33, v34
    v_cvt_pk_bf16_f32 v23, v23, v23
    v_and_b32 v23, 0xffff0000, v23
    v_sub_f32 v24, v24, v31
    v_cvt_pk_bf16_f32 v24, v24, v24
    v_and_b32 v24, 0xffff0000, v24
    v_mul_f32 v34, v24, v33
    v_fma_f32 v35, -v34, v32, v24
    v_fma_f32 v24, v35, v33, v34
    v_cvt_pk_bf16_f32 v24, v24, v24
    v_and_b32 v24, 0xffff0000, v24
    v_sub_f32 v25, v25, v31
    v_cvt_pk_bf16_f32 v25, v25, v25
    v_and_b32 v25, 0xffff0000, v25
    v_mul_f32 v34, v25, v33
    v_fma_f32 v35, -v34, v32, v25
    v_fma_f32 v25, v35, v33, v34
    v_cvt_pk_bf16_f32 v25, v25, v25
    v_and_b32 v25, 0xffff0000, v25
    v_sub_f32 v26, v26, v31
    v_cvt_pk_bf16_f32 v26, v26, v26
    v_and_b32 v26, 0xffff0000, v26
    v_mul_f32 v34, v26, v33
    v_fma_f32 v35, -v34, v32, v26
    v_fma_f32 v26, v35, v33, v34
    v_cvt_pk_bf16_f32 v26, v26, v26
    v_and_b32 v26, 0xffff0000, v26
    v_sub_f32 v27, v27, v31
    v_cvt_pk_bf16_f32 v27, v27, v27
    v_and_b32 v27, 0xffff0000, v27
    v_mul_f32 v34, v27, v33
    v_fma_f32 v35, -v34, v32, v27
    v_fma_f32 v27, v35, v33, v34
    v_cvt_pk_bf16_f32 v27, v27, v27
    v_and_b32 v27, 0xffff0000, v27
    v_sub_f32 v28, v28, v31
    v_cvt_pk_bf16_f32 v28, v28, v28
    v_and_b32 v28, 0xffff0000, v28
    v_mul_f32 v34, v28, v33
    v_fma_f32 v35, -v34, v32, v28
    v_fma_f32 v28, v35, v33, v34
    v_cvt_pk_bf16_f32 v28, v28, v28
    v_and_b32 v28, 0xffff0000, v28
    v_sub_f32 v29, v29, v31
    v_cvt_pk_bf16_f32 v29, v29, v29
    v_and_b32 v29, 0xffff0000, v29
    v_mul_f32 v34, v29, v33
    v_fma_f32 v35, -v34, v32, v29
    v_fma_f32 v29, v35, v33, v34
    v_cvt_pk_bf16_f32 v29, v29, v29
    v_and_b32 v29, 0xffff0000, v29
    v_sub_f32 v30, v30, v31
    v_cvt_pk_bf16_f32 v30, v30, v30
    v_and_b32 v30, 0xffff0000, v30
    v_mul_f32 v34, v30, v33
    v_fma_f32 v35, -v34, v32, v30
    v_fma_f32 v30, v35, v33, v34
    v_cvt_pk_bf16_f32 v30, v30, v30
    v_and_b32 v30, 0xffff0000, v30
    v_lshlrev_b32 v34, 5, v2
    ds_write_b128 v34, v[22:25] offset:0
    ds_write_b128 v34, v[26:29] offset:16
    v_lshlrev_b32 v34, 2, v2
    ds_write_b32 v34, v30 offset:2048
    v_and_b32 v34, 60, v34
    v_mov_b32 v35, 0
    ds_write_b32 v34, v35 offset:2304
    v_lshlrev_b32 v36, 2, v36
    ds_read_b32 v14, v36 offset:0
    ds_read_b32 v15, v36 offset:128
    ds_read_b32 v16, v36 offset:256
    ds_read_b32 v17, v36 offset:384
    ds_read_b32 v18, v36 offset:512
    ds_read_b32 v19, v36 offset:640
    ds_read_b32 v20, v36 offset:768
    ds_read_b32 v21, v36 offset:896
    ds_read_b32 v22, v36 offset:1024
    ds_read_b32 v23, v36 offset:1152
    ds_read_b32 v24, v36 offset:1280
    ds_read_b32 v25, v36 offset:1408
    ds_read_b32 v26, v36 offset:1536
    ds_read_b32 v27, v36 offset:1664
    ds_read_b32 v28, v36 offset:1792
    ds_read_b32 v29, v36 offset:1920
    ds_read_b32 v30, v36 offset:2048
    ds_read_b32 v31, v36 offset:2176
    v_mov_b32 v6, 0
    v_mov_b32 v7, 0
    v_mov_b32 v8, 0
    v_mov_b32 v9, 0
    v_mov_b32 v10, 0
    v_mov_b32 v11, 0
    v_mov_b32 v12, 0
    v_mov_b32 v13, 0
    s_waitcnt lgkmcnt(0)
    s_waitcnt vmcnt(33)
    v_lshlrev_b32 v32, 16, v40
    v_and_b32 v40, 0xffff0000, v40
    v_fmac_f32 v6, v14, v32
    v_fmac_f32 v7, v14, v40
    v_lshlrev_b32 v33, 16, v41
    v_and_b32 v41, 0xffff0000, v41
    v_fmac_f32 v8, v14, v33
    v_fmac_f32 v9, v14, v41
    v_lshlrev_b32 v32, 16, v42
    v_and_b32 v42, 0xffff0000, v42
    v_fmac_f32 v10, v14, v32
    v_fmac_f32 v11, v14, v42
    v_lshlrev_b32 v33, 16, v43
    v_and_b32 v43, 0xffff0000, v43
    v_fmac_f32 v12, v14, v33
    v_fmac_f32 v13, v14, v43
    s_waitcnt vmcnt(32)
    v_lshlrev_b32 v32, 16, v44
    v_and_b32 v44, 0xffff0000, v44
    v_fmac_f32 v6, v15, v32
    v_fmac_f32 v7, v15, v44
    v_lshlrev_b32 v33, 16, v45
    v_and_b32 v45, 0xffff0000, v45
    v_fmac_f32 v8, v15, v33
    v_fmac_f32 v9, v15, v45
    v_lshlrev_b32 v32, 16, v46
    v_and_b32 v46, 0xffff0000, v46
    v_fmac_f32 v10, v15, v32
    v_fmac_f32 v11, v15, v46
    v_lshlrev_b32 v33, 16, v47
    v_and_b32 v47, 0xffff0000, v47
    v_fmac_f32 v12, v15, v33
    v_fmac_f32 v13, v15, v47
    s_waitcnt vmcnt(31)
    v_lshlrev_b32 v32, 16, v48
    v_and_b32 v48, 0xffff0000, v48
    v_fmac_f32 v6, v16, v32
    v_fmac_f32 v7, v16, v48
    v_lshlrev_b32 v33, 16, v49
    v_and_b32 v49, 0xffff0000, v49
    v_fmac_f32 v8, v16, v33
    v_fmac_f32 v9, v16, v49
    v_lshlrev_b32 v32, 16, v50
    v_and_b32 v50, 0xffff0000, v50
    v_fmac_f32 v10, v16, v32
    v_fmac_f32 v11, v16, v50
    v_lshlrev_b32 v33, 16, v51
    v_and_b32 v51, 0xffff0000, v51
    v_fmac_f32 v12, v16, v33
    v_fmac_f32 v13, v16, v51
    s_waitcnt vmcnt(30)
    v_lshlrev_b32 v32, 16, v52
    v_and_b32 v52, 0xffff0000, v52
    v_fmac_f32 v6, v17, v32
    v_fmac_f32 v7, v17, v52
    v_lshlrev_b32 v33, 16, v53
    v_and_b32 v53, 0xffff0000, v53
    v_fmac_f32 v8, v17, v33
    v_fmac_f32 v9, v17, v53
    v_lshlrev_b32 v32, 16, v54
    v_and_b32 v54, 0xffff0000, v54
    v_fmac_f32 v10, v17, v32
    v_fmac_f32 v11, v17, v54
    v_lshlrev_b32 v33, 16, v55
    v_and_b32 v55, 0xffff0000, v55
    v_fmac_f32 v12, v17, v33
    v_fmac_f32 v13, v17, v55
    s_waitcnt vmcnt(29)
    v_lshlrev_b32 v32, 16, v56
    v_and_b32 v56, 0xffff0000, v56
    v_fmac_f32 v6, v18, v32
    v_fmac_f32 v7, v18, v56
    v_lshlrev_b32 v33, 16, v57
    v_and_b32 v57, 0xffff0000, v57
    v_fmac_f32 v8, v18, v33
    v_fmac_f32 v9, v18, v57
    v_lshlrev_b32 v32, 16, v58
    v_and_b32 v58, 0xffff0000, v58
    v_fmac_f32 v10, v18, v32
    v_fmac_f32 v11, v18, v58
    v_lshlrev_b32 v33, 16, v59
    v_and_b32 v59, 0xffff0000, v59
    v_fmac_f32 v12, v18, v33
    v_fmac_f32 v13, v18, v59
    s_waitcnt vmcnt(28)
    v_lshlrev_b32 v32, 16, v60
    v_and_b32 v60, 0xffff0000, v60
    v_fmac_f32 v6, v19, v32
    v_fmac_f32 v7, v19, v60
    v_lshlrev_b32 v33, 16, v61
    v_and_b32 v61, 0xffff0000, v61
    v_fmac_f32 v8, v19, v33
    v_fmac_f32 v9, v19, v61
    v_lshlrev_b32 v32, 16, v62
    v_and_b32 v62, 0xffff0000, v62
    v_fmac_f32 v10, v19, v32
    v_fmac_f32 v11, v19, v62
    v_lshlrev_b32 v33, 16, v63
    v_and_b32 v63, 0xffff0000, v63
    v_fmac_f32 v12, v19, v33
    v_fmac_f32 v13, v19, v63
    s_waitcnt vmcnt(27)
    v_lshlrev_b32 v32, 16, v64
    v_and_b32 v64, 0xffff0000, v64
    v_fmac_f32 v6, v20, v32
    v_fmac_f32 v7, v20, v64
    v_lshlrev_b32 v33, 16, v65
    v_and_b32 v65, 0xffff0000, v65
    v_fmac_f32 v8, v20, v33
    v_fmac_f32 v9, v20, v65
    v_lshlrev_b32 v32, 16, v66
    v_and_b32 v66, 0xffff0000, v66
    v_fmac_f32 v10, v20, v32
    v_fmac_f32 v11, v20, v66
    v_lshlrev_b32 v33, 16, v67
    v_and_b32 v67, 0xffff0000, v67
    v_fmac_f32 v12, v20, v33
    v_fmac_f32 v13, v20, v67
    s_waitcnt vmcnt(26)
    v_lshlrev_b32 v32, 16, v68
    v_and_b32 v68, 0xffff0000, v68
    v_fmac_f32 v6, v21, v32
    v_fmac_f32 v7, v21, v68
    v_lshlrev_b32 v33, 16, v69
    v_and_b32 v69, 0xffff0000, v69
    v_fmac_f32 v8, v21, v33
    v_fmac_f32 v9, v21, v69
    v_lshlrev_b32 v32, 16, v70
    v_and_b32 v70, 0xffff0000, v70
    v_fmac_f32 v10, v21, v32
    v_fmac_f32 v11, v21, v70
    v_lshlrev_b32 v33, 16, v71
    v_and_b32 v71, 0xffff0000, v71
    v_fmac_f32 v12, v21, v33
    v_fmac_f32 v13, v21, v71
    s_waitcnt vmcnt(25)
    v_lshlrev_b32 v32, 16, v72
    v_and_b32 v72, 0xffff0000, v72
    v_fmac_f32 v6, v22, v32
    v_fmac_f32 v7, v22, v72
    v_lshlrev_b32 v33, 16, v73
    v_and_b32 v73, 0xffff0000, v73
    v_fmac_f32 v8, v22, v33
    v_fmac_f32 v9, v22, v73
    v_lshlrev_b32 v32, 16, v74
    v_and_b32 v74, 0xffff0000, v74
    v_fmac_f32 v10, v22, v32
    v_fmac_f32 v11, v22, v74
    v_lshlrev_b32 v33, 16, v75
    v_and_b32 v75, 0xffff0000, v75
    v_fmac_f32 v12, v22, v33
    v_fmac_f32 v13, v22, v75
    s_waitcnt vmcnt(24)
    v_lshlrev_b32 v32, 16, v76
    v_and_b32 v76, 0xffff0000, v76
    v_fmac_f32 v6, v23, v32
    v_fmac_f32 v7, v23, v76
    v_lshlrev_b32 v33, 16, v77
    v_and_b32 v77, 0xffff0000, v77
    v_fmac_f32 v8, v23, v33
    v_fmac_f32 v9, v23, v77
    v_lshlrev_b32 v32, 16, v78
    v_and_b32 v78, 0xffff0000, v78
    v_fmac_f32 v10, v23, v32
    v_fmac_f32 v11, v23, v78
    v_lshlrev_b32 v33, 16, v79
    v_and_b32 v79, 0xffff0000, v79
    v_fmac_f32 v12, v23, v33
    v_fmac_f32 v13, v23, v79
    s_waitcnt vmcnt(23)
    v_lshlrev_b32 v32, 16, v80
    v_and_b32 v80, 0xffff0000, v80
    v_fmac_f32 v6, v24, v32
    v_fmac_f32 v7, v24, v80
    v_lshlrev_b32 v33, 16, v81
    v_and_b32 v81, 0xffff0000, v81
    v_fmac_f32 v8, v24, v33
    v_fmac_f32 v9, v24, v81
    v_lshlrev_b32 v32, 16, v82
    v_and_b32 v82, 0xffff0000, v82
    v_fmac_f32 v10, v24, v32
    v_fmac_f32 v11, v24, v82
    v_lshlrev_b32 v33, 16, v83
    v_and_b32 v83, 0xffff0000, v83
    v_fmac_f32 v12, v24, v33
    v_fmac_f32 v13, v24, v83
    s_waitcnt vmcnt(22)
    v_lshlrev_b32 v32, 16, v84
    v_and_b32 v84, 0xffff0000, v84
    v_fmac_f32 v6, v25, v32
    v_fmac_f32 v7, v25, v84
    v_lshlrev_b32 v33, 16, v85
    v_and_b32 v85, 0xffff0000, v85
    v_fmac_f32 v8, v25, v33
    v_fmac_f32 v9, v25, v85
    v_lshlrev_b32 v32, 16, v86
    v_and_b32 v86, 0xffff0000, v86
    v_fmac_f32 v10, v25, v32
    v_fmac_f32 v11, v25, v86
    v_lshlrev_b32 v33, 16, v87
    v_and_b32 v87, 0xffff0000, v87
    v_fmac_f32 v12, v25, v33
    v_fmac_f32 v13, v25, v87
    s_waitcnt vmcnt(21)
    v_lshlrev_b32 v32, 16, v88
    v_and_b32 v88, 0xffff0000, v88
    v_fmac_f32 v6, v26, v32
    v_fmac_f32 v7, v26, v88
    v_lshlrev_b32 v33, 16, v89
    v_and_b32 v89, 0xffff0000, v89
    v_fmac_f32 v8, v26, v33
    v_fmac_f32 v9, v26, v89
    v_lshlrev_b32 v32, 16, v90
    v_and_b32 v90, 0xffff0000, v90
    v_fmac_f32 v10, v26, v32
    v_fmac_f32 v11, v26, v90
    v_lshlrev_b32 v33, 16, v91
    v_and_b32 v91, 0xffff0000, v91
    v_fmac_f32 v12, v26, v33
    v_fmac_f32 v13, v26, v91
    s_waitcnt vmcnt(20)
    v_lshlrev_b32 v32, 16, v92
    v_and_b32 v92, 0xffff0000, v92
    v_fmac_f32 v6, v27, v32
    v_fmac_f32 v7, v27, v92
    v_lshlrev_b32 v33, 16, v93
    v_and_b32 v93, 0xffff0000, v93
    v_fmac_f32 v8, v27, v33
    v_fmac_f32 v9, v27, v93
    v_lshlrev_b32 v32, 16, v94
    v_and_b32 v94, 0xffff0000, v94
    v_fmac_f32 v10, v27, v32
    v_fmac_f32 v11, v27, v94
    v_lshlrev_b32 v33, 16, v95
    v_and_b32 v95, 0xffff0000, v95
    v_fmac_f32 v12, v27, v33
    v_fmac_f32 v13, v27, v95
    s_waitcnt vmcnt(19)
    v_lshlrev_b32 v32, 16, v96
    v_and_b32 v96, 0xffff0000, v96
    v_fmac_f32 v6, v28, v32
    v_fmac_f32 v7, v28, v96
    v_lshlrev_b32 v33, 16, v97
    v_and_b32 v97, 0xffff0000, v97
    v_fmac_f32 v8, v28, v33
    v_fmac_f32 v9, v28, v97
    v_lshlrev_b32 v32, 16, v98
    v_and_b32 v98, 0xffff0000, v98
    v_fmac_f32 v10, v28, v32
    v_fmac_f32 v11, v28, v98
    v_lshlrev_b32 v33, 16, v99
    v_and_b32 v99, 0xffff0000, v99
    v_fmac_f32 v12, v28, v33
    v_fmac_f32 v13, v28, v99
    s_waitcnt vmcnt(18)
    v_lshlrev_b32 v32, 16, v100
    v_and_b32 v100, 0xffff0000, v100
    v_fmac_f32 v6, v29, v32
    v_fmac_f32 v7, v29, v100
    v_lshlrev_b32 v33, 16, v101
    v_and_b32 v101, 0xffff0000, v101
    v_fmac_f32 v8, v29, v33
    v_fmac_f32 v9, v29, v101
    v_lshlrev_b32 v32, 16, v102
    v_and_b32 v102, 0xffff0000, v102
    v_fmac_f32 v10, v29, v32
    v_fmac_f32 v11, v29, v102
    v_lshlrev_b32 v33, 16, v103
    v_and_b32 v103, 0xffff0000, v103
    v_fmac_f32 v12, v29, v33
    v_fmac_f32 v13, v29, v103
    s_waitcnt vmcnt(17)
    v_lshlrev_b32 v32, 16, v104
    v_and_b32 v104, 0xffff0000, v104
    v_fmac_f32 v6, v30, v32
    v_fmac_f32 v7, v30, v104
    v_lshlrev_b32 v33, 16, v105
    v_and_b32 v105, 0xffff0000, v105
    v_fmac_f32 v8, v30, v33
    v_fmac_f32 v9, v30, v105
    v_lshlrev_b32 v32, 16, v106
    v_and_b32 v106, 0xffff0000, v106
    v_fmac_f32 v10, v30, v32
    v_fmac_f32 v11, v30, v106
    v_lshlrev_b32 v33, 16, v107
    v_and_b32 v107, 0xffff0000, v107
    v_fmac_f32 v12, v30, v33
    v_fmac_f32 v13, v30, v107
    s_waitcnt vmcnt(16)
    v_lshlrev_b32 v32, 16, v108
    v_and_b32 v108, 0xffff0000, v108
    v_fmac_f32 v6, v31, v32
    v_fmac_f32 v7, v31, v108
    v_lshlrev_b32 v33, 16, v109
    v_and_b32 v109, 0xffff0000, v109
    v_fmac_f32 v8, v31, v33
    v_fmac_f32 v9, v31, v109
    v_lshlrev_b32 v32, 16, v110
    v_and_b32 v110, 0xffff0000, v110
    v_fmac_f32 v10, v31, v32
    v_fmac_f32 v11, v31, v110
    v_lshlrev_b32 v33, 16, v111
    v_and_b32 v111, 0xffff0000, v111
    v_fmac_f32 v12, v31, v33
    v_fmac_f32 v13, v31, v111
    v_mov_b32 v32, v6
    s_nop 1
    v_permlane16_swap_b32 v6, v32
    s_nop 1
    v_add_f32 v6, v6, v32
    v_mov_b32 v32, v6
    s_nop 1
    v_permlane32_swap_b32 v6, v32
    s_nop 1
    v_add_f32 v6, v6, v32
    v_mov_b32 v32, v7
    s_nop 1
    v_permlane16_swap_b32 v7, v32
    s_nop 1
    v_add_f32 v7, v7, v32
    v_mov_b32 v32, v7
    s_nop 1
    v_permlane32_swap_b32 v7, v32
    s_nop 1
    v_add_f32 v7, v7, v32
    v_mov_b32 v32, v8
    s_nop 1
    v_permlane16_swap_b32 v8, v32
    s_nop 1
    v_add_f32 v8, v8, v32
    v_mov_b32 v32, v8
    s_nop 1
    v_permlane32_swap_b32 v8, v32
    s_nop 1
    v_add_f32 v8, v8, v32
    v_mov_b32 v32, v9
    s_nop 1
    v_permlane16_swap_b32 v9, v32
    s_nop 1
    v_add_f32 v9, v9, v32
    v_mov_b32 v32, v9
    s_nop 1
    v_permlane32_swap_b32 v9, v32
    s_nop 1
    v_add_f32 v9, v9, v32
    v_mov_b32 v32, v10
    s_nop 1
    v_permlane16_swap_b32 v10, v32
    s_nop 1
    v_add_f32 v10, v10, v32
    v_mov_b32 v32, v10
    s_nop 1
    v_permlane32_swap_b32 v10, v32
    s_nop 1
    v_add_f32 v10, v10, v32
    v_mov_b32 v32, v11
    s_nop 1
    v_permlane16_swap_b32 v11, v32
    s_nop 1
    v_add_f32 v11, v11, v32
    v_mov_b32 v32, v11
    s_nop 1
    v_permlane32_swap_b32 v11, v32
    s_nop 1
    v_add_f32 v11, v11, v32
    v_mov_b32 v32, v12
    s_nop 1
    v_permlane16_swap_b32 v12, v32
    s_nop 1
    v_add_f32 v12, v12, v32
    v_mov_b32 v32, v12
    s_nop 1
    v_permlane32_swap_b32 v12, v32
    s_nop 1
    v_add_f32 v12, v12, v32
    v_mov_b32 v32, v13
    s_nop 1
    v_permlane16_swap_b32 v13, v32
    s_nop 1
    v_add_f32 v13, v13, v32
    v_mov_b32 v32, v13
    s_nop 1
    v_permlane32_swap_b32 v13, v32
    s_nop 1
    v_add_f32 v13, v13, v32
    v_and_b32 v32, 15, v0
    v_lshlrev_b32 v32, 5, v32
    s_lshl_b32 s15, s3, 9
    v_add_u32 v32, s15, v32
    ds_write_b128 v32, v[6:9] offset:2560
    ds_write_b128 v32, v[10:13] offset:2576
    s_waitcnt lgkmcnt(0)
    s_barrier
    v_lshlrev_b32 v32, 3, v2
    ds_read_b64 v[14:15], v32 offset:2560
    ds_read_b64 v[16:17], v32 offset:3072
    ds_read_b64 v[18:19], v32 offset:3584
    ds_read_b64 v[20:21], v32 offset:4096
    ds_read_b64 v[22:23], v32 offset:4608
    ds_read_b64 v[24:25], v32 offset:5120
    ds_read_b64 v[26:27], v32 offset:5632
    ds_read_b64 v[28:29], v32 offset:6144
    s_waitcnt lgkmcnt(0)
    v_add_f32 v14, v14, v16
    v_add_f32 v15, v15, v17
    v_add_f32 v14, v14, v18
    v_add_f32 v15, v15, v19
    v_add_f32 v14, v14, v20
    v_add_f32 v15, v15, v21
    v_add_f32 v14, v14, v22
    v_add_f32 v15, v15, v23
    v_add_f32 v14, v14, v24
    v_add_f32 v15, v15, v25
    v_add_f32 v14, v14, v26
    v_add_f32 v15, v15, v27
    v_add_f32 v14, v14, v28
    v_add_f32 v15, v15, v29
    v_cvt_pk_bf16_f32 v14, v14, v15
    s_lshl_b32 s15, s3, 8
    v_lshlrev_b32 v32, 2, v2
    v_add_u32 v32, s15, v32
    ds_write_b32 v32, v14 offset:6656
    v_and_b32 v32, 15, v0
    v_lshlrev_b32 v32, 4, v32
    v_add_u32 v32, s15, v32
    s_waitcnt lgkmcnt(0)
    ds_read_b128 v[2:5], v32 offset:6656
    v_mov_b32 v6, 0
    v_mov_b32 v7, 0
    v_mov_b32 v8, 0
    v_mov_b32 v9, 0
    v_mov_b32 v10, 0
    v_mov_b32 v11, 0
    v_mov_b32 v12, 0
    v_mov_b32 v13, 0
    v_mov_b32 v14, 0xff800000
    v_mov_b32 v15, 0
    s_mov_b32 s74, 0xbfb8aa3b
    s_waitcnt lgkmcnt(0)
    s_waitcnt vmcnt(12)
    v_dot2_f32_bf16 v16, v116, v2, 0
    v_dot2_f32_bf16 v17, v120, v2, 0
    v_dot2_f32_bf16 v18, v124, v2, 0
    v_dot2_f32_bf16 v19, v128, v2, 0
    v_dot2_f32_bf16 v16, v117, v3, v16
    v_dot2_f32_bf16 v17, v121, v3, v17
    v_dot2_f32_bf16 v18, v125, v3, v18
    v_dot2_f32_bf16 v19, v129, v3, v19
    v_dot2_f32_bf16 v16, v118, v4, v16
    v_dot2_f32_bf16 v17, v122, v4, v17
    v_dot2_f32_bf16 v18, v126, v4, v18
    v_dot2_f32_bf16 v19, v130, v4, v19
    v_dot2_f32_bf16 v16, v119, v5, v16
    v_dot2_f32_bf16 v17, v123, v5, v17
    v_dot2_f32_bf16 v18, v127, v5, v18
    v_dot2_f32_bf16 v19, v131, v5, v19
    buffer_load_dwordx4 v[116:119], v1, s[44:47], s13 offen offset:0 nt
    buffer_load_dwordx4 v[120:123], v1, s[44:47], s13 offen offset:1024 nt
    buffer_load_dwordx4 v[124:127], v1, s[44:47], s13 offen offset:2048 nt
    buffer_load_dwordx4 v[128:131], v1, s[44:47], s13 offen offset:3072 nt
    v_add_f32_dpp v16, v16, v16 row_ror:8 row_mask:0xf bank_mask:0xf
    v_add_f32_dpp v17, v17, v17 row_ror:8 row_mask:0xf bank_mask:0xf
    v_add_f32_dpp v18, v18, v18 row_ror:8 row_mask:0xf bank_mask:0xf
    v_add_f32_dpp v19, v19, v19 row_ror:8 row_mask:0xf bank_mask:0xf
    v_add_f32_dpp v16, v16, v16 row_ror:4 row_mask:0xf bank_mask:0xf
    v_add_f32_dpp v17, v17, v17 row_ror:4 row_mask:0xf bank_mask:0xf
    v_add_f32_dpp v18, v18, v18 row_ror:4 row_mask:0xf bank_mask:0xf
    v_add_f32_dpp v19, v19, v19 row_ror:4 row_mask:0xf bank_mask:0xf
    v_add_f32_dpp v16, v16, v16 row_ror:2 row_mask:0xf bank_mask:0xf
    v_add_f32_dpp v17, v17, v17 row_ror:2 row_mask:0xf bank_mask:0xf
    v_add_f32_dpp v18, v18, v18 row_ror:2 row_mask:0xf bank_mask:0xf
    v_add_f32_dpp v19, v19, v19 row_ror:2 row_mask:0xf bank_mask:0xf
    v_add_f32_dpp v16, v16, v16 row_ror:1 row_mask:0xf bank_mask:0xf
    v_add_f32_dpp v17, v17, v17 row_ror:1 row_mask:0xf bank_mask:0xf
    v_add_f32_dpp v18, v18, v18 row_ror:1 row_mask:0xf bank_mask:0xf
    v_add_f32_dpp v19, v19, v19 row_ror:1 row_mask:0xf bank_mask:0xf
    v_cvt_pk_bf16_f32 v24, v16, v17
    v_cvt_pk_bf16_f32 v25, v18, v19
    v_lshlrev_b32 v16, 16, v24
    v_and_b32 v17, 0xffff0000, v24
    v_lshlrev_b32 v18, 16, v25
    v_and_b32 v19, 0xffff0000, v25
    v_mul_f32 v16, s71, v16
    v_mul_f32 v17, s71, v17
    v_mul_f32 v18, s71, v18
    v_mul_f32 v19, s71, v19
    v_cvt_pk_bf16_f32 v24, v16, v17
    v_cvt_pk_bf16_f32 v25, v18, v19
    v_lshlrev_b32 v16, 16, v24
    v_and_b32 v17, 0xffff0000, v24
    v_lshlrev_b32 v18, 16, v25
    v_and_b32 v19, 0xffff0000, v25
    v_max3_f32 v24, v16, v17, v18
    v_max3_f32 v24, v24, v19, v14
    v_mul_f32 v33, s74, v24
    v_fma_f32 v32, v14, s70, v33
    v_fma_f32 v20, v16, s70, v33
    v_fma_f32 v21, v17, s70, v33
    v_fma_f32 v22, v18, s70, v33
    v_fma_f32 v23, v19, s70, v33
    v_exp_f32 v32, v32
    v_exp_f32 v20, v20
    v_exp_f32 v21, v21
    v_exp_f32 v22, v22
    v_exp_f32 v23, v23
    v_mov_b32 v14, v24
    v_fma_f32 v15, v15, v32, v20
    v_add_f32 v24, v21, v22
    v_add_f32 v15, v15, v23
    v_add_f32 v15, v15, v24
    v_mul_f32 v6, v6, v32
    v_mul_f32 v7, v7, v32
    v_mul_f32 v8, v8, v32
    v_mul_f32 v9, v9, v32
    v_mul_f32 v10, v10, v32
    v_mul_f32 v11, v11, v32
    v_mul_f32 v12, v12, v32
    v_mul_f32 v13, v13, v32
    s_waitcnt vmcnt(12)
    v_lshlrev_b32 v24, 16, v132
    v_and_b32 v25, 0xffff0000, v132
    v_fmac_f32 v6, v20, v24
    v_fmac_f32 v7, v20, v25
    v_lshlrev_b32 v26, 16, v133
    v_and_b32 v27, 0xffff0000, v133
    v_fmac_f32 v8, v20, v26
    v_fmac_f32 v9, v20, v27
    v_lshlrev_b32 v24, 16, v134
    v_and_b32 v25, 0xffff0000, v134
    v_fmac_f32 v10, v20, v24
    v_fmac_f32 v11, v20, v25
    v_lshlrev_b32 v26, 16, v135
    v_and_b32 v27, 0xffff0000, v135
    v_fmac_f32 v12, v20, v26
    v_fmac_f32 v13, v20, v27
    v_lshlrev_b32 v24, 16, v136
    v_and_b32 v25, 0xffff0000, v136
    v_fmac_f32 v6, v21, v24
    v_fmac_f32 v7, v21, v25
    v_lshlrev_b32 v26, 16, v137
    v_and_b32 v27, 0xffff0000, v137
    v_fmac_f32 v8, v21, v26
    v_fmac_f32 v9, v21, v27
    v_lshlrev_b32 v24, 16, v138
    v_and_b32 v25, 0xffff0000, v138
    v_fmac_f32 v10, v21, v24
    v_fmac_f32 v11, v21, v25
    v_lshlrev_b32 v26, 16, v139
    v_and_b32 v27, 0xffff0000, v139
    v_fmac_f32 v12, v21, v26
    v_fmac_f32 v13, v21, v27
    v_lshlrev_b32 v24, 16, v140
    v_and_b32 v25, 0xffff0000, v140
    v_fmac_f32 v6, v22, v24
    v_fmac_f32 v7, v22, v25
    v_lshlrev_b32 v26, 16, v141
    v_and_b32 v27, 0xffff0000, v141
    v_fmac_f32 v8, v22, v26
    v_fmac_f32 v9, v22, v27
    v_lshlrev_b32 v24, 16, v142
    v_and_b32 v25, 0xffff0000, v142
    v_fmac_f32 v10, v22, v24
    v_fmac_f32 v11, v22, v25
    v_lshlrev_b32 v26, 16, v143
    v_and_b32 v27, 0xffff0000, v143
    v_fmac_f32 v12, v22, v26
    v_fmac_f32 v13, v22, v27
    v_lshlrev_b32 v24, 16, v144
    v_and_b32 v25, 0xffff0000, v144
    v_fmac_f32 v6, v23, v24
    v_fmac_f32 v7, v23, v25
    v_lshlrev_b32 v26, 16, v145
    v_and_b32 v27, 0xffff0000, v145
    v_fmac_f32 v8, v23, v26
    v_fmac_f32 v9, v23, v27
    v_lshlrev_b32 v24, 16, v146
    v_and_b32 v25, 0xffff0000, v146
    v_fmac_f32 v10, v23, v24
    v_fmac_f32 v11, v23, v25
    v_lshlrev_b32 v26, 16, v147
    v_and_b32 v27, 0xffff0000, v147
    v_fmac_f32 v12, v23, v26
    v_fmac_f32 v13, v23, v27
    buffer_load_dwordx4 v[132:135], v1, s[48:51], s13 offen offset:0 nt
    buffer_load_dwordx4 v[136:139], v1, s[48:51], s13 offen offset:1024 nt
    buffer_load_dwordx4 v[140:143], v1, s[48:51], s13 offen offset:2048 nt
    buffer_load_dwordx4 v[144:147], v1, s[48:51], s13 offen offset:3072 nt
    s_add_u32 s13, s13, 229376
    s_waitcnt vmcnt(12)
    v_dot2_f32_bf16 v16, v148, v2, 0
    v_dot2_f32_bf16 v17, v152, v2, 0
    v_dot2_f32_bf16 v18, v156, v2, 0
    v_dot2_f32_bf16 v19, v160, v2, 0
    v_dot2_f32_bf16 v16, v149, v3, v16
    v_dot2_f32_bf16 v17, v153, v3, v17
    v_dot2_f32_bf16 v18, v157, v3, v18
    v_dot2_f32_bf16 v19, v161, v3, v19
    v_dot2_f32_bf16 v16, v150, v4, v16
    v_dot2_f32_bf16 v17, v154, v4, v17
    v_dot2_f32_bf16 v18, v158, v4, v18
    v_dot2_f32_bf16 v19, v162, v4, v19
    v_dot2_f32_bf16 v16, v151, v5, v16
    v_dot2_f32_bf16 v17, v155, v5, v17
    v_dot2_f32_bf16 v18, v159, v5, v18
    v_dot2_f32_bf16 v19, v163, v5, v19
    buffer_load_dwordx4 v[148:151], v1, s[44:47], s13 offen offset:0 nt
    buffer_load_dwordx4 v[152:155], v1, s[44:47], s13 offen offset:1024 nt
    buffer_load_dwordx4 v[156:159], v1, s[44:47], s13 offen offset:2048 nt
    buffer_load_dwordx4 v[160:163], v1, s[44:47], s13 offen offset:3072 nt
    v_add_f32_dpp v16, v16, v16 row_ror:8 row_mask:0xf bank_mask:0xf
    v_add_f32_dpp v17, v17, v17 row_ror:8 row_mask:0xf bank_mask:0xf
    v_add_f32_dpp v18, v18, v18 row_ror:8 row_mask:0xf bank_mask:0xf
    v_add_f32_dpp v19, v19, v19 row_ror:8 row_mask:0xf bank_mask:0xf
    v_add_f32_dpp v16, v16, v16 row_ror:4 row_mask:0xf bank_mask:0xf
    v_add_f32_dpp v17, v17, v17 row_ror:4 row_mask:0xf bank_mask:0xf
    v_add_f32_dpp v18, v18, v18 row_ror:4 row_mask:0xf bank_mask:0xf
    v_add_f32_dpp v19, v19, v19 row_ror:4 row_mask:0xf bank_mask:0xf
    v_add_f32_dpp v16, v16, v16 row_ror:2 row_mask:0xf bank_mask:0xf
    v_add_f32_dpp v17, v17, v17 row_ror:2 row_mask:0xf bank_mask:0xf
    v_add_f32_dpp v18, v18, v18 row_ror:2 row_mask:0xf bank_mask:0xf
    v_add_f32_dpp v19, v19, v19 row_ror:2 row_mask:0xf bank_mask:0xf
    v_add_f32_dpp v16, v16, v16 row_ror:1 row_mask:0xf bank_mask:0xf
    v_add_f32_dpp v17, v17, v17 row_ror:1 row_mask:0xf bank_mask:0xf
    v_add_f32_dpp v18, v18, v18 row_ror:1 row_mask:0xf bank_mask:0xf
    v_add_f32_dpp v19, v19, v19 row_ror:1 row_mask:0xf bank_mask:0xf
    v_cvt_pk_bf16_f32 v24, v16, v17
    v_cvt_pk_bf16_f32 v25, v18, v19
    v_lshlrev_b32 v16, 16, v24
    v_and_b32 v17, 0xffff0000, v24
    v_lshlrev_b32 v18, 16, v25
    v_and_b32 v19, 0xffff0000, v25
    v_mul_f32 v16, s71, v16
    v_mul_f32 v17, s71, v17
    v_mul_f32 v18, s71, v18
    v_mul_f32 v19, s71, v19
    v_cvt_pk_bf16_f32 v24, v16, v17
    v_cvt_pk_bf16_f32 v25, v18, v19
    v_lshlrev_b32 v16, 16, v24
    v_and_b32 v17, 0xffff0000, v24
    v_lshlrev_b32 v18, 16, v25
    v_and_b32 v19, 0xffff0000, v25
    v_max3_f32 v24, v16, v17, v18
    v_max3_f32 v24, v24, v19, v14
    v_mul_f32 v33, s74, v24
    v_fma_f32 v32, v14, s70, v33
    v_fma_f32 v20, v16, s70, v33
    v_fma_f32 v21, v17, s70, v33
    v_fma_f32 v22, v18, s70, v33
    v_fma_f32 v23, v19, s70, v33
    v_exp_f32 v32, v32
    v_exp_f32 v20, v20
    v_exp_f32 v21, v21
    v_exp_f32 v22, v22
    v_exp_f32 v23, v23
    v_mov_b32 v14, v24
    v_fma_f32 v15, v15, v32, v20
    v_add_f32 v24, v21, v22
    v_add_f32 v15, v15, v23
    v_add_f32 v15, v15, v24
    v_mul_f32 v6, v6, v32
    v_mul_f32 v7, v7, v32
    v_mul_f32 v8, v8, v32
    v_mul_f32 v9, v9, v32
    v_mul_f32 v10, v10, v32
    v_mul_f32 v11, v11, v32
    v_mul_f32 v12, v12, v32
    v_mul_f32 v13, v13, v32
    s_waitcnt vmcnt(12)
    v_lshlrev_b32 v24, 16, v164
    v_and_b32 v25, 0xffff0000, v164
    v_fmac_f32 v6, v20, v24
    v_fmac_f32 v7, v20, v25
    v_lshlrev_b32 v26, 16, v165
    v_and_b32 v27, 0xffff0000, v165
    v_fmac_f32 v8, v20, v26
    v_fmac_f32 v9, v20, v27
    v_lshlrev_b32 v24, 16, v166
    v_and_b32 v25, 0xffff0000, v166
    v_fmac_f32 v10, v20, v24
    v_fmac_f32 v11, v20, v25
    v_lshlrev_b32 v26, 16, v167
    v_and_b32 v27, 0xffff0000, v167
    v_fmac_f32 v12, v20, v26
    v_fmac_f32 v13, v20, v27
    v_lshlrev_b32 v24, 16, v168
    v_and_b32 v25, 0xffff0000, v168
    v_fmac_f32 v6, v21, v24
    v_fmac_f32 v7, v21, v25
    v_lshlrev_b32 v26, 16, v169
    v_and_b32 v27, 0xffff0000, v169
    v_fmac_f32 v8, v21, v26
    v_fmac_f32 v9, v21, v27
    v_lshlrev_b32 v24, 16, v170
    v_and_b32 v25, 0xffff0000, v170
    v_fmac_f32 v10, v21, v24
    v_fmac_f32 v11, v21, v25
    v_lshlrev_b32 v26, 16, v171
    v_and_b32 v27, 0xffff0000, v171
    v_fmac_f32 v12, v21, v26
    v_fmac_f32 v13, v21, v27
    v_lshlrev_b32 v24, 16, v172
    v_and_b32 v25, 0xffff0000, v172
    v_fmac_f32 v6, v22, v24
    v_fmac_f32 v7, v22, v25
    v_lshlrev_b32 v26, 16, v173
    v_and_b32 v27, 0xffff0000, v173
    v_fmac_f32 v8, v22, v26
    v_fmac_f32 v9, v22, v27
    v_lshlrev_b32 v24, 16, v174
    v_and_b32 v25, 0xffff0000, v174
    v_fmac_f32 v10, v22, v24
    v_fmac_f32 v11, v22, v25
    v_lshlrev_b32 v26, 16, v175
    v_and_b32 v27, 0xffff0000, v175
    v_fmac_f32 v12, v22, v26
    v_fmac_f32 v13, v22, v27
    v_lshlrev_b32 v24, 16, v176
    v_and_b32 v25, 0xffff0000, v176
    v_fmac_f32 v6, v23, v24
    v_fmac_f32 v7, v23, v25
    v_lshlrev_b32 v26, 16, v177
    v_and_b32 v27, 0xffff0000, v177
    v_fmac_f32 v8, v23, v26
    v_fmac_f32 v9, v23, v27
    v_lshlrev_b32 v24, 16, v178
    v_and_b32 v25, 0xffff0000, v178
    v_fmac_f32 v10, v23, v24
    v_fmac_f32 v11, v23, v25
    v_lshlrev_b32 v26, 16, v179
    v_and_b32 v27, 0xffff0000, v179
    v_fmac_f32 v12, v23, v26
    v_fmac_f32 v13, v23, v27
    buffer_load_dwordx4 v[164:167], v1, s[48:51], s13 offen offset:0 nt
    buffer_load_dwordx4 v[168:171], v1, s[48:51], s13 offen offset:1024 nt
    buffer_load_dwordx4 v[172:175], v1, s[48:51], s13 offen offset:2048 nt
    buffer_load_dwordx4 v[176:179], v1, s[48:51], s13 offen offset:3072 nt
    s_add_u32 s13, s13, 229376
    v_mul_u32_u24 v37, 911, v0
    v_lshrrev_b32 v37, 16, v37
    v_mul_u32_u24 v38, 72, v37
    v_sub_u32 v38, v0, v38
    v_lshlrev_b32 v39, 4, v0
    v_cmp_gt_u32 vcc, 504, v0
    v_mov_b32 v35, 0x80000000
    s_nop 1
    v_cndmask_b32 v39, v35, v39, vcc
    s_mul_i32 s15, s8, 147456
    buffer_load_dwordx4 v[40:43], v39, s[56:59], s15 offen
    s_add_u32 s15, s15, 8064
    buffer_load_dwordx4 v[44:47], v39, s[56:59], s15 offen
    s_add_u32 s15, s15, 8064
    buffer_load_dwordx4 v[48:51], v39, s[56:59], s15 offen
    s_add_u32 s15, s15, 8064
    buffer_load_dwordx4 v[52:55], v39, s[56:59], s15 offen
    s_add_u32 s15, s15, 8064
    buffer_load_dwordx4 v[56:59], v39, s[56:59], s15 offen
    s_add_u32 s15, s15, 8064
    buffer_load_dwordx4 v[60:63], v39, s[56:59], s15 offen
    s_add_u32 s15, s15, 8064
    buffer_load_dwordx4 v[64:67], v39, s[56:59], s15 offen
    s_add_u32 s15, s15, 8064
    buffer_load_dwordx4 v[68:71], v39, s[56:59], s15 offen
    s_add_u32 s15, s15, 8064
    buffer_load_dwordx4 v[72:75], v39, s[56:59], s15 offen
    s_add_u32 s15, s15, 8064
    buffer_load_dwordx4 v[76:79], v39, s[56:59], s15 offen
    s_add_u32 s15, s15, 8064
    buffer_load_dwordx4 v[80:83], v39, s[56:59], s15 offen
    s_add_u32 s15, s15, 8064
    buffer_load_dwordx4 v[84:87], v39, s[56:59], s15 offen
    s_add_u32 s15, s15, 8064
    buffer_load_dwordx4 v[88:91], v39, s[56:59], s15 offen
    s_add_u32 s15, s15, 8064
    buffer_load_dwordx4 v[92:95], v39, s[56:59], s15 offen
    s_add_u32 s15, s15, 8064
    buffer_load_dwordx4 v[96:99], v39, s[56:59], s15 offen
    s_add_u32 s15, s15, 8064
    buffer_load_dwordx4 v[100:103], v39, s[56:59], s15 offen
    s_add_u32 s15, s15, 8064
    buffer_load_dwordx4 v[104:107], v39, s[56:59], s15 offen
    s_add_u32 s15, s15, 8064
    buffer_load_dwordx4 v[108:111], v39, s[56:59], s15 offen
    s_add_u32 s15, s15, 8064
    buffer_load_dwordx4 v[112:115], v39, s[56:59], s15 offen
    s_waitcnt vmcnt(31)
    v_dot2_f32_bf16 v16, v116, v2, 0
    v_dot2_f32_bf16 v17, v120, v2, 0
    v_dot2_f32_bf16 v18, v124, v2, 0
    v_dot2_f32_bf16 v19, v128, v2, 0
    v_dot2_f32_bf16 v16, v117, v3, v16
    v_dot2_f32_bf16 v17, v121, v3, v17
    v_dot2_f32_bf16 v18, v125, v3, v18
    v_dot2_f32_bf16 v19, v129, v3, v19
    v_dot2_f32_bf16 v16, v118, v4, v16
    v_dot2_f32_bf16 v17, v122, v4, v17
    v_dot2_f32_bf16 v18, v126, v4, v18
    v_dot2_f32_bf16 v19, v130, v4, v19
    v_dot2_f32_bf16 v16, v119, v5, v16
    v_dot2_f32_bf16 v17, v123, v5, v17
    v_dot2_f32_bf16 v18, v127, v5, v18
    v_dot2_f32_bf16 v19, v131, v5, v19
    buffer_load_dwordx4 v[116:119], v1, s[44:47], s13 offen offset:0 nt
    buffer_load_dwordx4 v[120:123], v1, s[44:47], s13 offen offset:1024 nt
    buffer_load_dwordx4 v[124:127], v1, s[44:47], s13 offen offset:2048 nt
    buffer_load_dwordx4 v[128:131], v1, s[44:47], s13 offen offset:3072 nt
    v_add_f32_dpp v16, v16, v16 row_ror:8 row_mask:0xf bank_mask:0xf
    v_add_f32_dpp v17, v17, v17 row_ror:8 row_mask:0xf bank_mask:0xf
    v_add_f32_dpp v18, v18, v18 row_ror:8 row_mask:0xf bank_mask:0xf
    v_add_f32_dpp v19, v19, v19 row_ror:8 row_mask:0xf bank_mask:0xf
    v_add_f32_dpp v16, v16, v16 row_ror:4 row_mask:0xf bank_mask:0xf
    v_add_f32_dpp v17, v17, v17 row_ror:4 row_mask:0xf bank_mask:0xf
    v_add_f32_dpp v18, v18, v18 row_ror:4 row_mask:0xf bank_mask:0xf
    v_add_f32_dpp v19, v19, v19 row_ror:4 row_mask:0xf bank_mask:0xf
    v_add_f32_dpp v16, v16, v16 row_ror:2 row_mask:0xf bank_mask:0xf
    v_add_f32_dpp v17, v17, v17 row_ror:2 row_mask:0xf bank_mask:0xf
    v_add_f32_dpp v18, v18, v18 row_ror:2 row_mask:0xf bank_mask:0xf
    v_add_f32_dpp v19, v19, v19 row_ror:2 row_mask:0xf bank_mask:0xf
    v_add_f32_dpp v16, v16, v16 row_ror:1 row_mask:0xf bank_mask:0xf
    v_add_f32_dpp v17, v17, v17 row_ror:1 row_mask:0xf bank_mask:0xf
    v_add_f32_dpp v18, v18, v18 row_ror:1 row_mask:0xf bank_mask:0xf
    v_add_f32_dpp v19, v19, v19 row_ror:1 row_mask:0xf bank_mask:0xf
    v_cvt_pk_bf16_f32 v24, v16, v17
    v_cvt_pk_bf16_f32 v25, v18, v19
    v_lshlrev_b32 v16, 16, v24
    v_and_b32 v17, 0xffff0000, v24
    v_lshlrev_b32 v18, 16, v25
    v_and_b32 v19, 0xffff0000, v25
    v_mul_f32 v16, s71, v16
    v_mul_f32 v17, s71, v17
    v_mul_f32 v18, s71, v18
    v_mul_f32 v19, s71, v19
    v_cvt_pk_bf16_f32 v24, v16, v17
    v_cvt_pk_bf16_f32 v25, v18, v19
    v_lshlrev_b32 v16, 16, v24
    v_and_b32 v17, 0xffff0000, v24
    v_lshlrev_b32 v18, 16, v25
    v_and_b32 v19, 0xffff0000, v25
    v_max3_f32 v24, v16, v17, v18
    v_max3_f32 v24, v24, v19, v14
    v_mul_f32 v33, s74, v24
    v_fma_f32 v32, v14, s70, v33
    v_fma_f32 v20, v16, s70, v33
    v_fma_f32 v21, v17, s70, v33
    v_fma_f32 v22, v18, s70, v33
    v_fma_f32 v23, v19, s70, v33
    v_exp_f32 v32, v32
    v_exp_f32 v20, v20
    v_exp_f32 v21, v21
    v_exp_f32 v22, v22
    v_exp_f32 v23, v23
    v_mov_b32 v14, v24
    v_fma_f32 v15, v15, v32, v20
    v_add_f32 v24, v21, v22
    v_add_f32 v15, v15, v23
    v_add_f32 v15, v15, v24
    v_mul_f32 v6, v6, v32
    v_mul_f32 v7, v7, v32
    v_mul_f32 v8, v8, v32
    v_mul_f32 v9, v9, v32
    v_mul_f32 v10, v10, v32
    v_mul_f32 v11, v11, v32
    v_mul_f32 v12, v12, v32
    v_mul_f32 v13, v13, v32
    s_waitcnt vmcnt(31)
    v_lshlrev_b32 v24, 16, v132
    v_and_b32 v25, 0xffff0000, v132
    v_fmac_f32 v6, v20, v24
    v_fmac_f32 v7, v20, v25
    v_lshlrev_b32 v26, 16, v133
    v_and_b32 v27, 0xffff0000, v133
    v_fmac_f32 v8, v20, v26
    v_fmac_f32 v9, v20, v27
    v_lshlrev_b32 v24, 16, v134
    v_and_b32 v25, 0xffff0000, v134
    v_fmac_f32 v10, v20, v24
    v_fmac_f32 v11, v20, v25
    v_lshlrev_b32 v26, 16, v135
    v_and_b32 v27, 0xffff0000, v135
    v_fmac_f32 v12, v20, v26
    v_fmac_f32 v13, v20, v27
    v_lshlrev_b32 v24, 16, v136
    v_and_b32 v25, 0xffff0000, v136
    v_fmac_f32 v6, v21, v24
    v_fmac_f32 v7, v21, v25
    v_lshlrev_b32 v26, 16, v137
    v_and_b32 v27, 0xffff0000, v137
    v_fmac_f32 v8, v21, v26
    v_fmac_f32 v9, v21, v27
    v_lshlrev_b32 v24, 16, v138
    v_and_b32 v25, 0xffff0000, v138
    v_fmac_f32 v10, v21, v24
    v_fmac_f32 v11, v21, v25
    v_lshlrev_b32 v26, 16, v139
    v_and_b32 v27, 0xffff0000, v139
    v_fmac_f32 v12, v21, v26
    v_fmac_f32 v13, v21, v27
    v_lshlrev_b32 v24, 16, v140
    v_and_b32 v25, 0xffff0000, v140
    v_fmac_f32 v6, v22, v24
    v_fmac_f32 v7, v22, v25
    v_lshlrev_b32 v26, 16, v141
    v_and_b32 v27, 0xffff0000, v141
    v_fmac_f32 v8, v22, v26
    v_fmac_f32 v9, v22, v27
    v_lshlrev_b32 v24, 16, v142
    v_and_b32 v25, 0xffff0000, v142
    v_fmac_f32 v10, v22, v24
    v_fmac_f32 v11, v22, v25
    v_lshlrev_b32 v26, 16, v143
    v_and_b32 v27, 0xffff0000, v143
    v_fmac_f32 v12, v22, v26
    v_fmac_f32 v13, v22, v27
    v_lshlrev_b32 v24, 16, v144
    v_and_b32 v25, 0xffff0000, v144
    v_fmac_f32 v6, v23, v24
    v_fmac_f32 v7, v23, v25
    v_lshlrev_b32 v26, 16, v145
    v_and_b32 v27, 0xffff0000, v145
    v_fmac_f32 v8, v23, v26
    v_fmac_f32 v9, v23, v27
    v_lshlrev_b32 v24, 16, v146
    v_and_b32 v25, 0xffff0000, v146
    v_fmac_f32 v10, v23, v24
    v_fmac_f32 v11, v23, v25
    v_lshlrev_b32 v26, 16, v147
    v_and_b32 v27, 0xffff0000, v147
    v_fmac_f32 v12, v23, v26
    v_fmac_f32 v13, v23, v27
    buffer_load_dwordx4 v[132:135], v1, s[48:51], s13 offen offset:0 nt
    buffer_load_dwordx4 v[136:139], v1, s[48:51], s13 offen offset:1024 nt
    buffer_load_dwordx4 v[140:143], v1, s[48:51], s13 offen offset:2048 nt
    buffer_load_dwordx4 v[144:147], v1, s[48:51], s13 offen offset:3072 nt
    s_add_u32 s13, s13, 229376
    s_waitcnt vmcnt(31)
    v_dot2_f32_bf16 v16, v148, v2, 0
    v_dot2_f32_bf16 v17, v152, v2, 0
    v_dot2_f32_bf16 v18, v156, v2, 0
    v_dot2_f32_bf16 v19, v160, v2, 0
    v_dot2_f32_bf16 v16, v149, v3, v16
    v_dot2_f32_bf16 v17, v153, v3, v17
    v_dot2_f32_bf16 v18, v157, v3, v18
    v_dot2_f32_bf16 v19, v161, v3, v19
    v_dot2_f32_bf16 v16, v150, v4, v16
    v_dot2_f32_bf16 v17, v154, v4, v17
    v_dot2_f32_bf16 v18, v158, v4, v18
    v_dot2_f32_bf16 v19, v162, v4, v19
    v_dot2_f32_bf16 v16, v151, v5, v16
    v_dot2_f32_bf16 v17, v155, v5, v17
    v_dot2_f32_bf16 v18, v159, v5, v18
    v_dot2_f32_bf16 v19, v163, v5, v19
    buffer_load_dwordx4 v[148:151], v1, s[44:47], s13 offen offset:0 nt
    buffer_load_dwordx4 v[152:155], v1, s[44:47], s13 offen offset:1024 nt
    buffer_load_dwordx4 v[156:159], v1, s[44:47], s13 offen offset:2048 nt
    buffer_load_dwordx4 v[160:163], v1, s[44:47], s13 offen offset:3072 nt
    v_add_f32_dpp v16, v16, v16 row_ror:8 row_mask:0xf bank_mask:0xf
    v_add_f32_dpp v17, v17, v17 row_ror:8 row_mask:0xf bank_mask:0xf
    v_add_f32_dpp v18, v18, v18 row_ror:8 row_mask:0xf bank_mask:0xf
    v_add_f32_dpp v19, v19, v19 row_ror:8 row_mask:0xf bank_mask:0xf
    v_add_f32_dpp v16, v16, v16 row_ror:4 row_mask:0xf bank_mask:0xf
    v_add_f32_dpp v17, v17, v17 row_ror:4 row_mask:0xf bank_mask:0xf
    v_add_f32_dpp v18, v18, v18 row_ror:4 row_mask:0xf bank_mask:0xf
    v_add_f32_dpp v19, v19, v19 row_ror:4 row_mask:0xf bank_mask:0xf
    v_add_f32_dpp v16, v16, v16 row_ror:2 row_mask:0xf bank_mask:0xf
    v_add_f32_dpp v17, v17, v17 row_ror:2 row_mask:0xf bank_mask:0xf
    v_add_f32_dpp v18, v18, v18 row_ror:2 row_mask:0xf bank_mask:0xf
    v_add_f32_dpp v19, v19, v19 row_ror:2 row_mask:0xf bank_mask:0xf
    v_add_f32_dpp v16, v16, v16 row_ror:1 row_mask:0xf bank_mask:0xf
    v_add_f32_dpp v17, v17, v17 row_ror:1 row_mask:0xf bank_mask:0xf
    v_add_f32_dpp v18, v18, v18 row_ror:1 row_mask:0xf bank_mask:0xf
    v_add_f32_dpp v19, v19, v19 row_ror:1 row_mask:0xf bank_mask:0xf
    v_cvt_pk_bf16_f32 v24, v16, v17
    v_cvt_pk_bf16_f32 v25, v18, v19
    v_lshlrev_b32 v16, 16, v24
    v_and_b32 v17, 0xffff0000, v24
    v_lshlrev_b32 v18, 16, v25
    v_and_b32 v19, 0xffff0000, v25
    v_mul_f32 v16, s71, v16
    v_mul_f32 v17, s71, v17
    v_mul_f32 v18, s71, v18
    v_mul_f32 v19, s71, v19
    v_cvt_pk_bf16_f32 v24, v16, v17
    v_cvt_pk_bf16_f32 v25, v18, v19
    v_lshlrev_b32 v16, 16, v24
    v_and_b32 v17, 0xffff0000, v24
    v_lshlrev_b32 v18, 16, v25
    v_and_b32 v19, 0xffff0000, v25
    v_max3_f32 v24, v16, v17, v18
    v_max3_f32 v24, v24, v19, v14
    v_mul_f32 v33, s74, v24
    v_fma_f32 v32, v14, s70, v33
    v_fma_f32 v20, v16, s70, v33
    v_fma_f32 v21, v17, s70, v33
    v_fma_f32 v22, v18, s70, v33
    v_fma_f32 v23, v19, s70, v33
    v_exp_f32 v32, v32
    v_exp_f32 v20, v20
    v_exp_f32 v21, v21
    v_exp_f32 v22, v22
    v_exp_f32 v23, v23
    v_mov_b32 v14, v24
    v_fma_f32 v15, v15, v32, v20
    v_add_f32 v24, v21, v22
    v_add_f32 v15, v15, v23
    v_add_f32 v15, v15, v24
    v_mul_f32 v6, v6, v32
    v_mul_f32 v7, v7, v32
    v_mul_f32 v8, v8, v32
    v_mul_f32 v9, v9, v32
    v_mul_f32 v10, v10, v32
    v_mul_f32 v11, v11, v32
    v_mul_f32 v12, v12, v32
    v_mul_f32 v13, v13, v32
    s_waitcnt vmcnt(31)
    v_lshlrev_b32 v24, 16, v164
    v_and_b32 v25, 0xffff0000, v164
    v_fmac_f32 v6, v20, v24
    v_fmac_f32 v7, v20, v25
    v_lshlrev_b32 v26, 16, v165
    v_and_b32 v27, 0xffff0000, v165
    v_fmac_f32 v8, v20, v26
    v_fmac_f32 v9, v20, v27
    v_lshlrev_b32 v24, 16, v166
    v_and_b32 v25, 0xffff0000, v166
    v_fmac_f32 v10, v20, v24
    v_fmac_f32 v11, v20, v25
    v_lshlrev_b32 v26, 16, v167
    v_and_b32 v27, 0xffff0000, v167
    v_fmac_f32 v12, v20, v26
    v_fmac_f32 v13, v20, v27
    v_lshlrev_b32 v24, 16, v168
    v_and_b32 v25, 0xffff0000, v168
    v_fmac_f32 v6, v21, v24
    v_fmac_f32 v7, v21, v25
    v_lshlrev_b32 v26, 16, v169
    v_and_b32 v27, 0xffff0000, v169
    v_fmac_f32 v8, v21, v26
    v_fmac_f32 v9, v21, v27
    v_lshlrev_b32 v24, 16, v170
    v_and_b32 v25, 0xffff0000, v170
    v_fmac_f32 v10, v21, v24
    v_fmac_f32 v11, v21, v25
    v_lshlrev_b32 v26, 16, v171
    v_and_b32 v27, 0xffff0000, v171
    v_fmac_f32 v12, v21, v26
    v_fmac_f32 v13, v21, v27
    v_lshlrev_b32 v24, 16, v172
    v_and_b32 v25, 0xffff0000, v172
    v_fmac_f32 v6, v22, v24
    v_fmac_f32 v7, v22, v25
    v_lshlrev_b32 v26, 16, v173
    v_and_b32 v27, 0xffff0000, v173
    v_fmac_f32 v8, v22, v26
    v_fmac_f32 v9, v22, v27
    v_lshlrev_b32 v24, 16, v174
    v_and_b32 v25, 0xffff0000, v174
    v_fmac_f32 v10, v22, v24
    v_fmac_f32 v11, v22, v25
    v_lshlrev_b32 v26, 16, v175
    v_and_b32 v27, 0xffff0000, v175
    v_fmac_f32 v12, v22, v26
    v_fmac_f32 v13, v22, v27
    v_lshlrev_b32 v24, 16, v176
    v_and_b32 v25, 0xffff0000, v176
    v_fmac_f32 v6, v23, v24
    v_fmac_f32 v7, v23, v25
    v_lshlrev_b32 v26, 16, v177
    v_and_b32 v27, 0xffff0000, v177
    v_fmac_f32 v8, v23, v26
    v_fmac_f32 v9, v23, v27
    v_lshlrev_b32 v24, 16, v178
    v_and_b32 v25, 0xffff0000, v178
    v_fmac_f32 v10, v23, v24
    v_fmac_f32 v11, v23, v25
    v_lshlrev_b32 v26, 16, v179
    v_and_b32 v27, 0xffff0000, v179
    v_fmac_f32 v12, v23, v26
    v_fmac_f32 v13, v23, v27
    buffer_load_dwordx4 v[164:167], v1, s[48:51], s13 offen offset:0 nt
    buffer_load_dwordx4 v[168:171], v1, s[48:51], s13 offen offset:1024 nt
    buffer_load_dwordx4 v[172:175], v1, s[48:51], s13 offen offset:2048 nt
    buffer_load_dwordx4 v[176:179], v1, s[48:51], s13 offen offset:3072 nt
    s_add_u32 s13, s13, 229376
    s_sub_u32 s12, s12, 4
L_loop:
    s_waitcnt vmcnt(12)
    v_dot2_f32_bf16 v16, v116, v2, 0
    v_dot2_f32_bf16 v17, v120, v2, 0
    v_dot2_f32_bf16 v18, v124, v2, 0
    v_dot2_f32_bf16 v19, v128, v2, 0
    v_dot2_f32_bf16 v16, v117, v3, v16
    v_dot2_f32_bf16 v17, v121, v3, v17
    v_dot2_f32_bf16 v18, v125, v3, v18
    v_dot2_f32_bf16 v19, v129, v3, v19
    v_dot2_f32_bf16 v16, v118, v4, v16
    v_dot2_f32_bf16 v17, v122, v4, v17
    v_dot2_f32_bf16 v18, v126, v4, v18
    v_dot2_f32_bf16 v19, v130, v4, v19
    v_dot2_f32_bf16 v16, v119, v5, v16
    v_dot2_f32_bf16 v17, v123, v5, v17
    v_dot2_f32_bf16 v18, v127, v5, v18
    v_dot2_f32_bf16 v19, v131, v5, v19
    buffer_load_dwordx4 v[116:119], v1, s[44:47], s13 offen offset:0 nt
    buffer_load_dwordx4 v[120:123], v1, s[44:47], s13 offen offset:1024 nt
    buffer_load_dwordx4 v[124:127], v1, s[44:47], s13 offen offset:2048 nt
    buffer_load_dwordx4 v[128:131], v1, s[44:47], s13 offen offset:3072 nt
    v_add_f32_dpp v16, v16, v16 row_ror:8 row_mask:0xf bank_mask:0xf
    v_add_f32_dpp v17, v17, v17 row_ror:8 row_mask:0xf bank_mask:0xf
    v_add_f32_dpp v18, v18, v18 row_ror:8 row_mask:0xf bank_mask:0xf
    v_add_f32_dpp v19, v19, v19 row_ror:8 row_mask:0xf bank_mask:0xf
    v_add_f32_dpp v16, v16, v16 row_ror:4 row_mask:0xf bank_mask:0xf
    v_add_f32_dpp v17, v17, v17 row_ror:4 row_mask:0xf bank_mask:0xf
    v_add_f32_dpp v18, v18, v18 row_ror:4 row_mask:0xf bank_mask:0xf
    v_add_f32_dpp v19, v19, v19 row_ror:4 row_mask:0xf bank_mask:0xf
    v_add_f32_dpp v16, v16, v16 row_ror:2 row_mask:0xf bank_mask:0xf
    v_add_f32_dpp v17, v17, v17 row_ror:2 row_mask:0xf bank_mask:0xf
    v_add_f32_dpp v18, v18, v18 row_ror:2 row_mask:0xf bank_mask:0xf
    v_add_f32_dpp v19, v19, v19 row_ror:2 row_mask:0xf bank_mask:0xf
    v_add_f32_dpp v16, v16, v16 row_ror:1 row_mask:0xf bank_mask:0xf
    v_add_f32_dpp v17, v17, v17 row_ror:1 row_mask:0xf bank_mask:0xf
    v_add_f32_dpp v18, v18, v18 row_ror:1 row_mask:0xf bank_mask:0xf
    v_add_f32_dpp v19, v19, v19 row_ror:1 row_mask:0xf bank_mask:0xf
    v_cvt_pk_bf16_f32 v24, v16, v17
    v_cvt_pk_bf16_f32 v25, v18, v19
    v_lshlrev_b32 v16, 16, v24
    v_and_b32 v17, 0xffff0000, v24
    v_lshlrev_b32 v18, 16, v25
    v_and_b32 v19, 0xffff0000, v25
    v_mul_f32 v16, s71, v16
    v_mul_f32 v17, s71, v17
    v_mul_f32 v18, s71, v18
    v_mul_f32 v19, s71, v19
    v_cvt_pk_bf16_f32 v24, v16, v17
    v_cvt_pk_bf16_f32 v25, v18, v19
    v_lshlrev_b32 v16, 16, v24
    v_and_b32 v17, 0xffff0000, v24
    v_lshlrev_b32 v18, 16, v25
    v_and_b32 v19, 0xffff0000, v25
    v_max3_f32 v24, v16, v17, v18
    v_max3_f32 v24, v24, v19, v14
    v_mul_f32 v33, s74, v24
    v_fma_f32 v32, v14, s70, v33
    v_fma_f32 v20, v16, s70, v33
    v_fma_f32 v21, v17, s70, v33
    v_fma_f32 v22, v18, s70, v33
    v_fma_f32 v23, v19, s70, v33
    v_exp_f32 v32, v32
    v_exp_f32 v20, v20
    v_exp_f32 v21, v21
    v_exp_f32 v22, v22
    v_exp_f32 v23, v23
    v_mov_b32 v14, v24
    v_fma_f32 v15, v15, v32, v20
    v_add_f32 v24, v21, v22
    v_add_f32 v15, v15, v23
    v_add_f32 v15, v15, v24
    v_mul_f32 v6, v6, v32
    v_mul_f32 v7, v7, v32
    v_mul_f32 v8, v8, v32
    v_mul_f32 v9, v9, v32
    v_mul_f32 v10, v10, v32
    v_mul_f32 v11, v11, v32
    v_mul_f32 v12, v12, v32
    v_mul_f32 v13, v13, v32
    s_waitcnt vmcnt(12)
    v_lshlrev_b32 v24, 16, v132
    v_and_b32 v25, 0xffff0000, v132
    v_fmac_f32 v6, v20, v24
    v_fmac_f32 v7, v20, v25
    v_lshlrev_b32 v26, 16, v133
    v_and_b32 v27, 0xffff0000, v133
    v_fmac_f32 v8, v20, v26
    v_fmac_f32 v9, v20, v27
    v_lshlrev_b32 v24, 16, v134
    v_and_b32 v25, 0xffff0000, v134
    v_fmac_f32 v10, v20, v24
    v_fmac_f32 v11, v20, v25
    v_lshlrev_b32 v26, 16, v135
    v_and_b32 v27, 0xffff0000, v135
    v_fmac_f32 v12, v20, v26
    v_fmac_f32 v13, v20, v27
    v_lshlrev_b32 v24, 16, v136
    v_and_b32 v25, 0xffff0000, v136
    v_fmac_f32 v6, v21, v24
    v_fmac_f32 v7, v21, v25
    v_lshlrev_b32 v26, 16, v137
    v_and_b32 v27, 0xffff0000, v137
    v_fmac_f32 v8, v21, v26
    v_fmac_f32 v9, v21, v27
    v_lshlrev_b32 v24, 16, v138
    v_and_b32 v25, 0xffff0000, v138
    v_fmac_f32 v10, v21, v24
    v_fmac_f32 v11, v21, v25
    v_lshlrev_b32 v26, 16, v139
    v_and_b32 v27, 0xffff0000, v139
    v_fmac_f32 v12, v21, v26
    v_fmac_f32 v13, v21, v27
    v_lshlrev_b32 v24, 16, v140
    v_and_b32 v25, 0xffff0000, v140
    v_fmac_f32 v6, v22, v24
    v_fmac_f32 v7, v22, v25
    v_lshlrev_b32 v26, 16, v141
    v_and_b32 v27, 0xffff0000, v141
    v_fmac_f32 v8, v22, v26
    v_fmac_f32 v9, v22, v27
    v_lshlrev_b32 v24, 16, v142
    v_and_b32 v25, 0xffff0000, v142
    v_fmac_f32 v10, v22, v24
    v_fmac_f32 v11, v22, v25
    v_lshlrev_b32 v26, 16, v143
    v_and_b32 v27, 0xffff0000, v143
    v_fmac_f32 v12, v22, v26
    v_fmac_f32 v13, v22, v27
    v_lshlrev_b32 v24, 16, v144
    v_and_b32 v25, 0xffff0000, v144
    v_fmac_f32 v6, v23, v24
    v_fmac_f32 v7, v23, v25
    v_lshlrev_b32 v26, 16, v145
    v_and_b32 v27, 0xffff0000, v145
    v_fmac_f32 v8, v23, v26
    v_fmac_f32 v9, v23, v27
    v_lshlrev_b32 v24, 16, v146
    v_and_b32 v25, 0xffff0000, v146
    v_fmac_f32 v10, v23, v24
    v_fmac_f32 v11, v23, v25
    v_lshlrev_b32 v26, 16, v147
    v_and_b32 v27, 0xffff0000, v147
    v_fmac_f32 v12, v23, v26
    v_fmac_f32 v13, v23, v27
    buffer_load_dwordx4 v[132:135], v1, s[48:51], s13 offen offset:0 nt
    buffer_load_dwordx4 v[136:139], v1, s[48:51], s13 offen offset:1024 nt
    buffer_load_dwordx4 v[140:143], v1, s[48:51], s13 offen offset:2048 nt
    buffer_load_dwordx4 v[144:147], v1, s[48:51], s13 offen offset:3072 nt
    s_add_u32 s13, s13, 229376
    s_sub_u32 s12, s12, 1
    s_cmp_eq_u32 s12, 0
    s_cbranch_scc1 L_loop_done
    s_waitcnt vmcnt(12)
    v_dot2_f32_bf16 v16, v148, v2, 0
    v_dot2_f32_bf16 v17, v152, v2, 0
    v_dot2_f32_bf16 v18, v156, v2, 0
    v_dot2_f32_bf16 v19, v160, v2, 0
    v_dot2_f32_bf16 v16, v149, v3, v16
    v_dot2_f32_bf16 v17, v153, v3, v17
    v_dot2_f32_bf16 v18, v157, v3, v18
    v_dot2_f32_bf16 v19, v161, v3, v19
    v_dot2_f32_bf16 v16, v150, v4, v16
    v_dot2_f32_bf16 v17, v154, v4, v17
    v_dot2_f32_bf16 v18, v158, v4, v18
    v_dot2_f32_bf16 v19, v162, v4, v19
    v_dot2_f32_bf16 v16, v151, v5, v16
    v_dot2_f32_bf16 v17, v155, v5, v17
    v_dot2_f32_bf16 v18, v159, v5, v18
    v_dot2_f32_bf16 v19, v163, v5, v19
    buffer_load_dwordx4 v[148:151], v1, s[44:47], s13 offen offset:0 nt
    buffer_load_dwordx4 v[152:155], v1, s[44:47], s13 offen offset:1024 nt
    buffer_load_dwordx4 v[156:159], v1, s[44:47], s13 offen offset:2048 nt
    buffer_load_dwordx4 v[160:163], v1, s[44:47], s13 offen offset:3072 nt
    v_add_f32_dpp v16, v16, v16 row_ror:8 row_mask:0xf bank_mask:0xf
    v_add_f32_dpp v17, v17, v17 row_ror:8 row_mask:0xf bank_mask:0xf
    v_add_f32_dpp v18, v18, v18 row_ror:8 row_mask:0xf bank_mask:0xf
    v_add_f32_dpp v19, v19, v19 row_ror:8 row_mask:0xf bank_mask:0xf
    v_add_f32_dpp v16, v16, v16 row_ror:4 row_mask:0xf bank_mask:0xf
    v_add_f32_dpp v17, v17, v17 row_ror:4 row_mask:0xf bank_mask:0xf
    v_add_f32_dpp v18, v18, v18 row_ror:4 row_mask:0xf bank_mask:0xf
    v_add_f32_dpp v19, v19, v19 row_ror:4 row_mask:0xf bank_mask:0xf
    v_add_f32_dpp v16, v16, v16 row_ror:2 row_mask:0xf bank_mask:0xf
    v_add_f32_dpp v17, v17, v17 row_ror:2 row_mask:0xf bank_mask:0xf
    v_add_f32_dpp v18, v18, v18 row_ror:2 row_mask:0xf bank_mask:0xf
    v_add_f32_dpp v19, v19, v19 row_ror:2 row_mask:0xf bank_mask:0xf
    v_add_f32_dpp v16, v16, v16 row_ror:1 row_mask:0xf bank_mask:0xf
    v_add_f32_dpp v17, v17, v17 row_ror:1 row_mask:0xf bank_mask:0xf
    v_add_f32_dpp v18, v18, v18 row_ror:1 row_mask:0xf bank_mask:0xf
    v_add_f32_dpp v19, v19, v19 row_ror:1 row_mask:0xf bank_mask:0xf
    v_cvt_pk_bf16_f32 v24, v16, v17
    v_cvt_pk_bf16_f32 v25, v18, v19
    v_lshlrev_b32 v16, 16, v24
    v_and_b32 v17, 0xffff0000, v24
    v_lshlrev_b32 v18, 16, v25
    v_and_b32 v19, 0xffff0000, v25
    v_mul_f32 v16, s71, v16
    v_mul_f32 v17, s71, v17
    v_mul_f32 v18, s71, v18
    v_mul_f32 v19, s71, v19
    v_cvt_pk_bf16_f32 v24, v16, v17
    v_cvt_pk_bf16_f32 v25, v18, v19
    v_lshlrev_b32 v16, 16, v24
    v_and_b32 v17, 0xffff0000, v24
    v_lshlrev_b32 v18, 16, v25
    v_and_b32 v19, 0xffff0000, v25
    v_max3_f32 v24, v16, v17, v18
    v_max3_f32 v24, v24, v19, v14
    v_mul_f32 v33, s74, v24
    v_fma_f32 v32, v14, s70, v33
    v_fma_f32 v20, v16, s70, v33
    v_fma_f32 v21, v17, s70, v33
    v_fma_f32 v22, v18, s70, v33
    v_fma_f32 v23, v19, s70, v33
    v_exp_f32 v32, v32
    v_exp_f32 v20, v20
    v_exp_f32 v21, v21
    v_exp_f32 v22, v22
    v_exp_f32 v23, v23
    v_mov_b32 v14, v24
    v_fma_f32 v15, v15, v32, v20
    v_add_f32 v24, v21, v22
    v_add_f32 v15, v15, v23
    v_add_f32 v15, v15, v24
    v_mul_f32 v6, v6, v32
    v_mul_f32 v7, v7, v32
    v_mul_f32 v8, v8, v32
    v_mul_f32 v9, v9, v32
    v_mul_f32 v10, v10, v32
    v_mul_f32 v11, v11, v32
    v_mul_f32 v12, v12, v32
    v_mul_f32 v13, v13, v32
    s_waitcnt vmcnt(12)
    v_lshlrev_b32 v24, 16, v164
    v_and_b32 v25, 0xffff0000, v164
    v_fmac_f32 v6, v20, v24
    v_fmac_f32 v7, v20, v25
    v_lshlrev_b32 v26, 16, v165
    v_and_b32 v27, 0xffff0000, v165
    v_fmac_f32 v8, v20, v26
    v_fmac_f32 v9, v20, v27
    v_lshlrev_b32 v24, 16, v166
    v_and_b32 v25, 0xffff0000, v166
    v_fmac_f32 v10, v20, v24
    v_fmac_f32 v11, v20, v25
    v_lshlrev_b32 v26, 16, v167
    v_and_b32 v27, 0xffff0000, v167
    v_fmac_f32 v12, v20, v26
    v_fmac_f32 v13, v20, v27
    v_lshlrev_b32 v24, 16, v168
    v_and_b32 v25, 0xffff0000, v168
    v_fmac_f32 v6, v21, v24
    v_fmac_f32 v7, v21, v25
    v_lshlrev_b32 v26, 16, v169
    v_and_b32 v27, 0xffff0000, v169
    v_fmac_f32 v8, v21, v26
    v_fmac_f32 v9, v21, v27
    v_lshlrev_b32 v24, 16, v170
    v_and_b32 v25, 0xffff0000, v170
    v_fmac_f32 v10, v21, v24
    v_fmac_f32 v11, v21, v25
    v_lshlrev_b32 v26, 16, v171
    v_and_b32 v27, 0xffff0000, v171
    v_fmac_f32 v12, v21, v26
    v_fmac_f32 v13, v21, v27
    v_lshlrev_b32 v24, 16, v172
    v_and_b32 v25, 0xffff0000, v172
    v_fmac_f32 v6, v22, v24
    v_fmac_f32 v7, v22, v25
    v_lshlrev_b32 v26, 16, v173
    v_and_b32 v27, 0xffff0000, v173
    v_fmac_f32 v8, v22, v26
    v_fmac_f32 v9, v22, v27
    v_lshlrev_b32 v24, 16, v174
    v_and_b32 v25, 0xffff0000, v174
    v_fmac_f32 v10, v22, v24
    v_fmac_f32 v11, v22, v25
    v_lshlrev_b32 v26, 16, v175
    v_and_b32 v27, 0xffff0000, v175
    v_fmac_f32 v12, v22, v26
    v_fmac_f32 v13, v22, v27
    v_lshlrev_b32 v24, 16, v176
    v_and_b32 v25, 0xffff0000, v176
    v_fmac_f32 v6, v23, v24
    v_fmac_f32 v7, v23, v25
    v_lshlrev_b32 v26, 16, v177
    v_and_b32 v27, 0xffff0000, v177
    v_fmac_f32 v8, v23, v26
    v_fmac_f32 v9, v23, v27
    v_lshlrev_b32 v24, 16, v178
    v_and_b32 v25, 0xffff0000, v178
    v_fmac_f32 v10, v23, v24
    v_fmac_f32 v11, v23, v25
    v_lshlrev_b32 v26, 16, v179
    v_and_b32 v27, 0xffff0000, v179
    v_fmac_f32 v12, v23, v26
    v_fmac_f32 v13, v23, v27
    buffer_load_dwordx4 v[164:167], v1, s[48:51], s13 offen offset:0 nt
    buffer_load_dwordx4 v[168:171], v1, s[48:51], s13 offen offset:1024 nt
    buffer_load_dwordx4 v[172:175], v1, s[48:51], s13 offen offset:2048 nt
    buffer_load_dwordx4 v[176:179], v1, s[48:51], s13 offen offset:3072 nt
    s_add_u32 s13, s13, 229376
    s_sub_u32 s12, s12, 1
    s_cmp_eq_u32 s12, 0
    s_cbranch_scc0 L_loop
L_loop_done:
    s_waitcnt vmcnt(0)
    v_mov_b32 v16, v14
    v_mov_b32 v32, v16
    s_nop 1
    v_permlane16_swap_b32 v16, v32
    s_nop 1
    v_max_f32 v16, v16, v32
    v_mov_b32 v32, v16
    s_nop 1
    v_permlane32_swap_b32 v16, v32
    s_nop 1
    v_max_f32 v16, v16, v32
    v_sub_f32 v17, v14, v16
    v_mul_f32 v17, s70, v17
    v_exp_f32 v17, v17
    s_nop 0
    v_mul_f32 v15, v15, v17
    v_mul_f32 v6, v6, v17
    v_mul_f32 v7, v7, v17
    v_mul_f32 v8, v8, v17
    v_mul_f32 v9, v9, v17
    v_mul_f32 v10, v10, v17
    v_mul_f32 v11, v11, v17
    v_mul_f32 v12, v12, v17
    v_mul_f32 v13, v13, v17
    v_mov_b32 v32, v15
    s_nop 1
    v_permlane16_swap_b32 v15, v32
    s_nop 1
    v_add_f32 v15, v15, v32
    v_mov_b32 v32, v15
    s_nop 1
    v_permlane32_swap_b32 v15, v32
    s_nop 1
    v_add_f32 v15, v15, v32
    v_mov_b32 v32, v6
    s_nop 1
    v_permlane16_swap_b32 v6, v32
    s_nop 1
    v_add_f32 v6, v6, v32
    v_mov_b32 v32, v6
    s_nop 1
    v_permlane32_swap_b32 v6, v32
    s_nop 1
    v_add_f32 v6, v6, v32
    v_mov_b32 v32, v7
    s_nop 1
    v_permlane16_swap_b32 v7, v32
    s_nop 1
    v_add_f32 v7, v7, v32
    v_mov_b32 v32, v7
    s_nop 1
    v_permlane32_swap_b32 v7, v32
    s_nop 1
    v_add_f32 v7, v7, v32
    v_mov_b32 v32, v8
    s_nop 1
    v_permlane16_swap_b32 v8, v32
    s_nop 1
    v_add_f32 v8, v8, v32
    v_mov_b32 v32, v8
    s_nop 1
    v_permlane32_swap_b32 v8, v32
    s_nop 1
    v_add_f32 v8, v8, v32
    v_mov_b32 v32, v9
    s_nop 1
    v_permlane16_swap_b32 v9, v32
    s_nop 1
    v_add_f32 v9, v9, v32
    v_mov_b32 v32, v9
    s_nop 1
    v_permlane32_swap_b32 v9, v32
    s_nop 1
    v_add_f32 v9, v9, v32
    v_mov_b32 v32, v10
    s_nop 1
    v_permlane16_swap_b32 v10, v32
    s_nop 1
    v_add_f32 v10, v10, v32
    v_mov_b32 v32, v10
    s_nop 1
    v_permlane32_swap_b32 v10, v32
    s_nop 1
    v_add_f32 v10, v10, v32
    v_mov_b32 v32, v11
    s_nop 1
    v_permlane16_swap_b32 v11, v32
    s_nop 1
    v_add_f32 v11, v11, v32
    v_mov_b32 v32, v11
    s_nop 1
    v_permlane32_swap_b32 v11, v32
    s_nop 1
    v_add_f32 v11, v11, v32
    v_mov_b32 v32, v12
    s_nop 1
    v_permlane16_swap_b32 v12, v32
    s_nop 1
    v_add_f32 v12, v12, v32
    v_mov_b32 v32, v12
    s_nop 1
    v_permlane32_swap_b32 v12, v32
    s_nop 1
    v_add_f32 v12, v12, v32
    v_mov_b32 v32, v13
    s_nop 1
    v_permlane16_swap_b32 v13, v32
    s_nop 1
    v_add_f32 v13, v13, v32
    v_mov_b32 v32, v13
    s_nop 1
    v_permlane32_swap_b32 v13, v32
    s_nop 1
    v_add_f32 v13, v13, v32
    v_and_b32 v32, 15, v0
    v_lshlrev_b32 v32, 5, v32
    s_lshl_b32 s15, s3, 9
    v_add_u32 v32, s15, v32
    ds_write_b128 v32, v[6:9] offset:8704
    ds_write_b128 v32, v[10:13] offset:8720
    s_lshl_b32 s15, s3, 3
    v_mov_b32 v32, s15
    v_mov_b32 v17, v15
    ds_write_b64 v32, v[16:17] offset:12800
    s_waitcnt lgkmcnt(0)
    s_barrier
    v_mov_b32 v32, 0
    ds_read_b64 v[16:17], v32 offset:12800
    ds_read_b64 v[18:19], v32 offset:12808
    ds_read_b64 v[20:21], v32 offset:12816
    ds_read_b64 v[22:23], v32 offset:12824
    ds_read_b64 v[24:25], v32 offset:12832
    ds_read_b64 v[26:27], v32 offset:12840
    ds_read_b64 v[28:29], v32 offset:12848
    ds_read_b64 v[30:31], v32 offset:12856
    v_and_b32 v2, 63, v0
    v_lshlrev_b32 v33, 3, v2
    ds_read_b64 v[116:117], v33 offset:8704
    ds_read_b64 v[118:119], v33 offset:9216
    ds_read_b64 v[120:121], v33 offset:9728
    ds_read_b64 v[122:123], v33 offset:10240
    ds_read_b64 v[124:125], v33 offset:10752
    ds_read_b64 v[126:127], v33 offset:11264
    ds_read_b64 v[128:129], v33 offset:11776
    ds_read_b64 v[130:131], v33 offset:12288
    s_waitcnt lgkmcnt(0)
    v_max3_f32 v14, v16, v18, v20
    v_max3_f32 v14, v14, v22, v24
    v_max3_f32 v14, v14, v26, v28
    v_max_f32 v14, v14, v30
    v_sub_f32 v16, v16, v14
    v_mul_f32 v16, s70, v16
    v_exp_f32 v16, v16
    v_sub_f32 v18, v18, v14
    v_mul_f32 v18, s70, v18
    v_exp_f32 v18, v18
    v_sub_f32 v20, v20, v14
    v_mul_f32 v20, s70, v20
    v_exp_f32 v20, v20
    v_sub_f32 v22, v22, v14
    v_mul_f32 v22, s70, v22
    v_exp_f32 v22, v22
    v_sub_f32 v24, v24, v14
    v_mul_f32 v24, s70, v24
    v_exp_f32 v24, v24
    v_sub_f32 v26, v26, v14
    v_mul_f32 v26, s70, v26
    v_exp_f32 v26, v26
    v_sub_f32 v28, v28, v14
    v_mul_f32 v28, s70, v28
    v_exp_f32 v28, v28
    v_sub_f32 v30, v30, v14
    v_mul_f32 v30, s70, v30
    v_exp_f32 v30, v30
    v_mov_b32 v15, 0
    v_mov_b32 v6, 0
    v_mov_b32 v7, 0
    v_fmac_f32 v15, v16, v17
    v_fmac_f32 v6, v16, v116
    v_fmac_f32 v7, v16, v117
    v_fmac_f32 v15, v18, v19
    v_fmac_f32 v6, v18, v118
    v_fmac_f32 v7, v18, v119
    v_fmac_f32 v15, v20, v21
    v_fmac_f32 v6, v20, v120
    v_fmac_f32 v7, v20, v121
    v_fmac_f32 v15, v22, v23
    v_fmac_f32 v6, v22, v122
    v_fmac_f32 v7, v22, v123
    v_fmac_f32 v15, v24, v25
    v_fmac_f32 v6, v24, v124
    v_fmac_f32 v7, v24, v125
    v_fmac_f32 v15, v26, v27
    v_fmac_f32 v6, v26, v126
    v_fmac_f32 v7, v26, v127
    v_fmac_f32 v15, v28, v29
    v_fmac_f32 v6, v28, v128
    v_fmac_f32 v7, v28, v129
    v_fmac_f32 v15, v30, v31
    v_fmac_f32 v6, v30, v130
    v_fmac_f32 v7, v30, v131
    s_mul_i32 s15, s3, 544
    v_add_u32 v33, s15, v33
    ds_write_b64 v33, v[6:7] offset:12928
    v_and_b32 v33, 7, v2
    v_lshlrev_b32 v33, 2, v33
    v_add_u32 v33, s15, v33
    v_mov_b32 v8, 0
    ds_write_b32 v33, v8 offset:13440
    s_lshl_b32 s9, s8, 3
    s_add_u32 s9, s9, s7
    s_lshl_b32 s10, s9, 3
    s_add_u32 s10, s10, 589824
    v_cmp_eq_u32 vcc, 0, v0
    s_nop 1
    s_and_saveexec_b64 s[72:73], vcc
    s_cbranch_execz L_skip_ml
    v_mov_b32 v33, 0
    buffer_store_dwordx2 v[14:15], v33, s[64:67], s10 offen
L_skip_ml:
    s_mov_b64 exec, s[72:73]
    s_mul_i32 s9, s9, 2304
    v_lshlrev_b32 v36, 2, v37
    v_add_u32 v36, s15, v36
    v_add_u32 v36, 12928, v36
    s_waitcnt lgkmcnt(0)
    ds_read_b32 v14, v36 offset:0
    ds_read_b32 v15, v36 offset:28
    ds_read_b32 v16, v36 offset:56
    ds_read_b32 v17, v36 offset:84
    ds_read_b32 v18, v36 offset:112
    ds_read_b32 v19, v36 offset:140
    ds_read_b32 v20, v36 offset:168
    ds_read_b32 v21, v36 offset:196
    ds_read_b32 v22, v36 offset:224
    ds_read_b32 v23, v36 offset:252
    ds_read_b32 v24, v36 offset:280
    ds_read_b32 v25, v36 offset:308
    ds_read_b32 v26, v36 offset:336
    ds_read_b32 v27, v36 offset:364
    ds_read_b32 v28, v36 offset:392
    ds_read_b32 v29, v36 offset:420
    ds_read_b32 v30, v36 offset:448
    ds_read_b32 v31, v36 offset:476
    ds_read_b32 v32, v36 offset:504
    v_mov_b32 v6, 0
    v_mov_b32 v7, 0
    v_mov_b32 v8, 0
    v_mov_b32 v9, 0
    v_mov_b32 v10, 0
    v_mov_b32 v11, 0
    v_mov_b32 v12, 0
    v_mov_b32 v13, 0
    s_waitcnt vmcnt(0) lgkmcnt(0)
    v_lshlrev_b32 v39, 16, v40
    v_and_b32 v40, 0xffff0000, v40
    v_fmac_f32 v6, v14, v39
    v_fmac_f32 v7, v14, v40
    v_lshlrev_b32 v39, 16, v41
    v_and_b32 v41, 0xffff0000, v41
    v_fmac_f32 v8, v14, v39
    v_fmac_f32 v9, v14, v41
    v_lshlrev_b32 v39, 16, v42
    v_and_b32 v42, 0xffff0000, v42
    v_fmac_f32 v10, v14, v39
    v_fmac_f32 v11, v14, v42
    v_lshlrev_b32 v39, 16, v43
    v_and_b32 v43, 0xffff0000, v43
    v_fmac_f32 v12, v14, v39
    v_fmac_f32 v13, v14, v43
    v_lshlrev_b32 v39, 16, v44
    v_and_b32 v44, 0xffff0000, v44
    v_fmac_f32 v6, v15, v39
    v_fmac_f32 v7, v15, v44
    v_lshlrev_b32 v39, 16, v45
    v_and_b32 v45, 0xffff0000, v45
    v_fmac_f32 v8, v15, v39
    v_fmac_f32 v9, v15, v45
    v_lshlrev_b32 v39, 16, v46
    v_and_b32 v46, 0xffff0000, v46
    v_fmac_f32 v10, v15, v39
    v_fmac_f32 v11, v15, v46
    v_lshlrev_b32 v39, 16, v47
    v_and_b32 v47, 0xffff0000, v47
    v_fmac_f32 v12, v15, v39
    v_fmac_f32 v13, v15, v47
    v_lshlrev_b32 v39, 16, v48
    v_and_b32 v48, 0xffff0000, v48
    v_fmac_f32 v6, v16, v39
    v_fmac_f32 v7, v16, v48
    v_lshlrev_b32 v39, 16, v49
    v_and_b32 v49, 0xffff0000, v49
    v_fmac_f32 v8, v16, v39
    v_fmac_f32 v9, v16, v49
    v_lshlrev_b32 v39, 16, v50
    v_and_b32 v50, 0xffff0000, v50
    v_fmac_f32 v10, v16, v39
    v_fmac_f32 v11, v16, v50
    v_lshlrev_b32 v39, 16, v51
    v_and_b32 v51, 0xffff0000, v51
    v_fmac_f32 v12, v16, v39
    v_fmac_f32 v13, v16, v51
    v_lshlrev_b32 v39, 16, v52
    v_and_b32 v52, 0xffff0000, v52
    v_fmac_f32 v6, v17, v39
    v_fmac_f32 v7, v17, v52
    v_lshlrev_b32 v39, 16, v53
    v_and_b32 v53, 0xffff0000, v53
    v_fmac_f32 v8, v17, v39
    v_fmac_f32 v9, v17, v53
    v_lshlrev_b32 v39, 16, v54
    v_and_b32 v54, 0xffff0000, v54
    v_fmac_f32 v10, v17, v39
    v_fmac_f32 v11, v17, v54
    v_lshlrev_b32 v39, 16, v55
    v_and_b32 v55, 0xffff0000, v55
    v_fmac_f32 v12, v17, v39
    v_fmac_f32 v13, v17, v55
    v_lshlrev_b32 v39, 16, v56
    v_and_b32 v56, 0xffff0000, v56
    v_fmac_f32 v6, v18, v39
    v_fmac_f32 v7, v18, v56
    v_lshlrev_b32 v39, 16, v57
    v_and_b32 v57, 0xffff0000, v57
    v_fmac_f32 v8, v18, v39
    v_fmac_f32 v9, v18, v57
    v_lshlrev_b32 v39, 16, v58
    v_and_b32 v58, 0xffff0000, v58
    v_fmac_f32 v10, v18, v39
    v_fmac_f32 v11, v18, v58
    v_lshlrev_b32 v39, 16, v59
    v_and_b32 v59, 0xffff0000, v59
    v_fmac_f32 v12, v18, v39
    v_fmac_f32 v13, v18, v59
    v_lshlrev_b32 v39, 16, v60
    v_and_b32 v60, 0xffff0000, v60
    v_fmac_f32 v6, v19, v39
    v_fmac_f32 v7, v19, v60
    v_lshlrev_b32 v39, 16, v61
    v_and_b32 v61, 0xffff0000, v61
    v_fmac_f32 v8, v19, v39
    v_fmac_f32 v9, v19, v61
    v_lshlrev_b32 v39, 16, v62
    v_and_b32 v62, 0xffff0000, v62
    v_fmac_f32 v10, v19, v39
    v_fmac_f32 v11, v19, v62
    v_lshlrev_b32 v39, 16, v63
    v_and_b32 v63, 0xffff0000, v63
    v_fmac_f32 v12, v19, v39
    v_fmac_f32 v13, v19, v63
    v_lshlrev_b32 v39, 16, v64
    v_and_b32 v64, 0xffff0000, v64
    v_fmac_f32 v6, v20, v39
    v_fmac_f32 v7, v20, v64
    v_lshlrev_b32 v39, 16, v65
    v_and_b32 v65, 0xffff0000, v65
    v_fmac_f32 v8, v20, v39
    v_fmac_f32 v9, v20, v65
    v_lshlrev_b32 v39, 16, v66
    v_and_b32 v66, 0xffff0000, v66
    v_fmac_f32 v10, v20, v39
    v_fmac_f32 v11, v20, v66
    v_lshlrev_b32 v39, 16, v67
    v_and_b32 v67, 0xffff0000, v67
    v_fmac_f32 v12, v20, v39
    v_fmac_f32 v13, v20, v67
    v_lshlrev_b32 v39, 16, v68
    v_and_b32 v68, 0xffff0000, v68
    v_fmac_f32 v6, v21, v39
    v_fmac_f32 v7, v21, v68
    v_lshlrev_b32 v39, 16, v69
    v_and_b32 v69, 0xffff0000, v69
    v_fmac_f32 v8, v21, v39
    v_fmac_f32 v9, v21, v69
    v_lshlrev_b32 v39, 16, v70
    v_and_b32 v70, 0xffff0000, v70
    v_fmac_f32 v10, v21, v39
    v_fmac_f32 v11, v21, v70
    v_lshlrev_b32 v39, 16, v71
    v_and_b32 v71, 0xffff0000, v71
    v_fmac_f32 v12, v21, v39
    v_fmac_f32 v13, v21, v71
    v_lshlrev_b32 v39, 16, v72
    v_and_b32 v72, 0xffff0000, v72
    v_fmac_f32 v6, v22, v39
    v_fmac_f32 v7, v22, v72
    v_lshlrev_b32 v39, 16, v73
    v_and_b32 v73, 0xffff0000, v73
    v_fmac_f32 v8, v22, v39
    v_fmac_f32 v9, v22, v73
    v_lshlrev_b32 v39, 16, v74
    v_and_b32 v74, 0xffff0000, v74
    v_fmac_f32 v10, v22, v39
    v_fmac_f32 v11, v22, v74
    v_lshlrev_b32 v39, 16, v75
    v_and_b32 v75, 0xffff0000, v75
    v_fmac_f32 v12, v22, v39
    v_fmac_f32 v13, v22, v75
    v_lshlrev_b32 v39, 16, v76
    v_and_b32 v76, 0xffff0000, v76
    v_fmac_f32 v6, v23, v39
    v_fmac_f32 v7, v23, v76
    v_lshlrev_b32 v39, 16, v77
    v_and_b32 v77, 0xffff0000, v77
    v_fmac_f32 v8, v23, v39
    v_fmac_f32 v9, v23, v77
    v_lshlrev_b32 v39, 16, v78
    v_and_b32 v78, 0xffff0000, v78
    v_fmac_f32 v10, v23, v39
    v_fmac_f32 v11, v23, v78
    v_lshlrev_b32 v39, 16, v79
    v_and_b32 v79, 0xffff0000, v79
    v_fmac_f32 v12, v23, v39
    v_fmac_f32 v13, v23, v79
    v_lshlrev_b32 v39, 16, v80
    v_and_b32 v80, 0xffff0000, v80
    v_fmac_f32 v6, v24, v39
    v_fmac_f32 v7, v24, v80
    v_lshlrev_b32 v39, 16, v81
    v_and_b32 v81, 0xffff0000, v81
    v_fmac_f32 v8, v24, v39
    v_fmac_f32 v9, v24, v81
    v_lshlrev_b32 v39, 16, v82
    v_and_b32 v82, 0xffff0000, v82
    v_fmac_f32 v10, v24, v39
    v_fmac_f32 v11, v24, v82
    v_lshlrev_b32 v39, 16, v83
    v_and_b32 v83, 0xffff0000, v83
    v_fmac_f32 v12, v24, v39
    v_fmac_f32 v13, v24, v83
    v_lshlrev_b32 v39, 16, v84
    v_and_b32 v84, 0xffff0000, v84
    v_fmac_f32 v6, v25, v39
    v_fmac_f32 v7, v25, v84
    v_lshlrev_b32 v39, 16, v85
    v_and_b32 v85, 0xffff0000, v85
    v_fmac_f32 v8, v25, v39
    v_fmac_f32 v9, v25, v85
    v_lshlrev_b32 v39, 16, v86
    v_and_b32 v86, 0xffff0000, v86
    v_fmac_f32 v10, v25, v39
    v_fmac_f32 v11, v25, v86
    v_lshlrev_b32 v39, 16, v87
    v_and_b32 v87, 0xffff0000, v87
    v_fmac_f32 v12, v25, v39
    v_fmac_f32 v13, v25, v87
    v_lshlrev_b32 v39, 16, v88
    v_and_b32 v88, 0xffff0000, v88
    v_fmac_f32 v6, v26, v39
    v_fmac_f32 v7, v26, v88
    v_lshlrev_b32 v39, 16, v89
    v_and_b32 v89, 0xffff0000, v89
    v_fmac_f32 v8, v26, v39
    v_fmac_f32 v9, v26, v89
    v_lshlrev_b32 v39, 16, v90
    v_and_b32 v90, 0xffff0000, v90
    v_fmac_f32 v10, v26, v39
    v_fmac_f32 v11, v26, v90
    v_lshlrev_b32 v39, 16, v91
    v_and_b32 v91, 0xffff0000, v91
    v_fmac_f32 v12, v26, v39
    v_fmac_f32 v13, v26, v91
    v_lshlrev_b32 v39, 16, v92
    v_and_b32 v92, 0xffff0000, v92
    v_fmac_f32 v6, v27, v39
    v_fmac_f32 v7, v27, v92
    v_lshlrev_b32 v39, 16, v93
    v_and_b32 v93, 0xffff0000, v93
    v_fmac_f32 v8, v27, v39
    v_fmac_f32 v9, v27, v93
    v_lshlrev_b32 v39, 16, v94
    v_and_b32 v94, 0xffff0000, v94
    v_fmac_f32 v10, v27, v39
    v_fmac_f32 v11, v27, v94
    v_lshlrev_b32 v39, 16, v95
    v_and_b32 v95, 0xffff0000, v95
    v_fmac_f32 v12, v27, v39
    v_fmac_f32 v13, v27, v95
    v_lshlrev_b32 v39, 16, v96
    v_and_b32 v96, 0xffff0000, v96
    v_fmac_f32 v6, v28, v39
    v_fmac_f32 v7, v28, v96
    v_lshlrev_b32 v39, 16, v97
    v_and_b32 v97, 0xffff0000, v97
    v_fmac_f32 v8, v28, v39
    v_fmac_f32 v9, v28, v97
    v_lshlrev_b32 v39, 16, v98
    v_and_b32 v98, 0xffff0000, v98
    v_fmac_f32 v10, v28, v39
    v_fmac_f32 v11, v28, v98
    v_lshlrev_b32 v39, 16, v99
    v_and_b32 v99, 0xffff0000, v99
    v_fmac_f32 v12, v28, v39
    v_fmac_f32 v13, v28, v99
    v_lshlrev_b32 v39, 16, v100
    v_and_b32 v100, 0xffff0000, v100
    v_fmac_f32 v6, v29, v39
    v_fmac_f32 v7, v29, v100
    v_lshlrev_b32 v39, 16, v101
    v_and_b32 v101, 0xffff0000, v101
    v_fmac_f32 v8, v29, v39
    v_fmac_f32 v9, v29, v101
    v_lshlrev_b32 v39, 16, v102
    v_and_b32 v102, 0xffff0000, v102
    v_fmac_f32 v10, v29, v39
    v_fmac_f32 v11, v29, v102
    v_lshlrev_b32 v39, 16, v103
    v_and_b32 v103, 0xffff0000, v103
    v_fmac_f32 v12, v29, v39
    v_fmac_f32 v13, v29, v103
    v_lshlrev_b32 v39, 16, v104
    v_and_b32 v104, 0xffff0000, v104
    v_fmac_f32 v6, v30, v39
    v_fmac_f32 v7, v30, v104
    v_lshlrev_b32 v39, 16, v105
    v_and_b32 v105, 0xffff0000, v105
    v_fmac_f32 v8, v30, v39
    v_fmac_f32 v9, v30, v105
    v_lshlrev_b32 v39, 16, v106
    v_and_b32 v106, 0xffff0000, v106
    v_fmac_f32 v10, v30, v39
    v_fmac_f32 v11, v30, v106
    v_lshlrev_b32 v39, 16, v107
    v_and_b32 v107, 0xffff0000, v107
    v_fmac_f32 v12, v30, v39
    v_fmac_f32 v13, v30, v107
    v_lshlrev_b32 v39, 16, v108
    v_and_b32 v108, 0xffff0000, v108
    v_fmac_f32 v6, v31, v39
    v_fmac_f32 v7, v31, v108
    v_lshlrev_b32 v39, 16, v109
    v_and_b32 v109, 0xffff0000, v109
    v_fmac_f32 v8, v31, v39
    v_fmac_f32 v9, v31, v109
    v_lshlrev_b32 v39, 16, v110
    v_and_b32 v110, 0xffff0000, v110
    v_fmac_f32 v10, v31, v39
    v_fmac_f32 v11, v31, v110
    v_lshlrev_b32 v39, 16, v111
    v_and_b32 v111, 0xffff0000, v111
    v_fmac_f32 v12, v31, v39
    v_fmac_f32 v13, v31, v111
    v_lshlrev_b32 v39, 16, v112
    v_and_b32 v112, 0xffff0000, v112
    v_fmac_f32 v6, v32, v39
    v_fmac_f32 v7, v32, v112
    v_lshlrev_b32 v39, 16, v113
    v_and_b32 v113, 0xffff0000, v113
    v_fmac_f32 v8, v32, v39
    v_fmac_f32 v9, v32, v113
    v_lshlrev_b32 v39, 16, v114
    v_and_b32 v114, 0xffff0000, v114
    v_fmac_f32 v10, v32, v39
    v_fmac_f32 v11, v32, v114
    v_lshlrev_b32 v39, 16, v115
    v_and_b32 v115, 0xffff0000, v115
    v_fmac_f32 v12, v32, v39
    v_fmac_f32 v13, v32, v115
    v_mul_u32_u24 v39, 2304, v37
    v_lshl_add_u32 v39, v38, 5, v39
    ds_write_b128 v39, v[6:9] offset:17408
    ds_write_b128 v39, v[10:13] offset:17424
    s_waitcnt lgkmcnt(0)
    s_barrier
    v_cmp_gt_u32 vcc, 144, v0
    s_nop 1
    s_and_saveexec_b64 s[72:73], vcc
    s_cbranch_execz L_done
    v_lshlrev_b32 v39, 4, v0
    ds_read_b128 v[40:43], v39 offset:17408
    ds_read_b128 v[44:47], v39 offset:19712
    ds_read_b128 v[48:51], v39 offset:22016
    ds_read_b128 v[52:55], v39 offset:24320
    ds_read_b128 v[56:59], v39 offset:26624
    ds_read_b128 v[60:63], v39 offset:28928
    ds_read_b128 v[64:67], v39 offset:31232
    s_waitcnt lgkmcnt(0)
    v_add_f32 v40, v40, v44
    v_add_f32 v41, v41, v45
    v_add_f32 v42, v42, v46
    v_add_f32 v43, v43, v47
    v_add_f32 v40, v40, v48
    v_add_f32 v41, v41, v49
    v_add_f32 v42, v42, v50
    v_add_f32 v43, v43, v51
    v_add_f32 v40, v40, v52
    v_add_f32 v41, v41, v53
    v_add_f32 v42, v42, v54
    v_add_f32 v43, v43, v55
    v_add_f32 v40, v40, v56
    v_add_f32 v41, v41, v57
    v_add_f32 v42, v42, v58
    v_add_f32 v43, v43, v59
    v_add_f32 v40, v40, v60
    v_add_f32 v41, v41, v61
    v_add_f32 v42, v42, v62
    v_add_f32 v43, v43, v63
    v_add_f32 v40, v40, v64
    v_add_f32 v41, v41, v65
    v_add_f32 v42, v42, v66
    v_add_f32 v43, v43, v67
    buffer_store_dwordx4 v[40:43], v39, s[64:67], s9 offen
    s_branch L_done
L_ffn:
    s_lshl_b32 s8, s4, 2
    s_add_u32 s8, s8, s5
    s_sub_u32 s8, s8, 28
    s_mov_b32 s52, s28
    s_and_b32 s53, s29, 0xffff
    s_mov_b32 s54, 5308416
    s_mov_b32 s55, 0x00020000
    s_mov_b32 s60, s30
    s_and_b32 s61, s31, 0xffff
    s_mov_b32 s62, 5308416
    s_mov_b32 s63, 0x00020000
    s_mov_b32 s56, s32
    s_and_b32 s57, s33, 0xffff
    s_add_u32 s58, s8, 1
    s_mul_i32 s58, s58, 165888
    s_mov_b32 s59, 0x00020000
    v_mul_u32_u24 v36, 3641, v0
    v_lshrrev_b32 v36, 16, v36
    v_mul_u32_u24 v37, 18, v36
    v_sub_u32 v37, v0, v37
    v_mul_u32_u24 v38, 9216, v36
    v_lshl_add_u32 v38, v37, 4, v38
    v_cmp_gt_u32 vcc, 504, v0
    v_mov_b32 v35, 0x80000000
    s_nop 1
    v_cndmask_b32 v38, v35, v38, vcc
    s_mul_i32 s15, s8, 288
    buffer_load_dwordx4 v[40:43], v38, s[52:55], s15 offen
    buffer_load_dwordx4 v[124:127], v38, s[60:63], s15 offen
    s_add_u32 s15, s15, 258048
    buffer_load_dwordx4 v[44:47], v38, s[52:55], s15 offen
    buffer_load_dwordx4 v[128:131], v38, s[60:63], s15 offen
    s_add_u32 s15, s15, 258048
    buffer_load_dwordx4 v[48:51], v38, s[52:55], s15 offen
    buffer_load_dwordx4 v[132:135], v38, s[60:63], s15 offen
    s_add_u32 s15, s15, 258048
    buffer_load_dwordx4 v[52:55], v38, s[52:55], s15 offen
    buffer_load_dwordx4 v[136:139], v38, s[60:63], s15 offen
    s_add_u32 s15, s15, 258048
    buffer_load_dwordx4 v[56:59], v38, s[52:55], s15 offen
    buffer_load_dwordx4 v[140:143], v38, s[60:63], s15 offen
    s_add_u32 s15, s15, 258048
    buffer_load_dwordx4 v[60:63], v38, s[52:55], s15 offen
    buffer_load_dwordx4 v[144:147], v38, s[60:63], s15 offen
    s_add_u32 s15, s15, 258048
    buffer_load_dwordx4 v[64:67], v38, s[52:55], s15 offen
    buffer_load_dwordx4 v[148:151], v38, s[60:63], s15 offen
    s_add_u32 s15, s15, 258048
    buffer_load_dwordx4 v[68:71], v38, s[52:55], s15 offen
    buffer_load_dwordx4 v[152:155], v38, s[60:63], s15 offen
    s_add_u32 s15, s15, 258048
    buffer_load_dwordx4 v[72:75], v38, s[52:55], s15 offen
    buffer_load_dwordx4 v[156:159], v38, s[60:63], s15 offen
    s_add_u32 s15, s15, 258048
    buffer_load_dwordx4 v[76:79], v38, s[52:55], s15 offen
    buffer_load_dwordx4 v[160:163], v38, s[60:63], s15 offen
    s_add_u32 s15, s15, 258048
    buffer_load_dwordx4 v[80:83], v38, s[52:55], s15 offen
    buffer_load_dwordx4 v[164:167], v38, s[60:63], s15 offen
    s_add_u32 s15, s15, 258048
    buffer_load_dwordx4 v[84:87], v38, s[52:55], s15 offen
    buffer_load_dwordx4 v[168:171], v38, s[60:63], s15 offen
    s_add_u32 s15, s15, 258048
    buffer_load_dwordx4 v[88:91], v38, s[52:55], s15 offen
    buffer_load_dwordx4 v[172:175], v38, s[60:63], s15 offen
    s_add_u32 s15, s15, 258048
    buffer_load_dwordx4 v[92:95], v38, s[52:55], s15 offen
    buffer_load_dwordx4 v[176:179], v38, s[60:63], s15 offen
    s_add_u32 s15, s15, 258048
    buffer_load_dwordx4 v[96:99], v38, s[52:55], s15 offen
    buffer_load_dwordx4 v[180:183], v38, s[60:63], s15 offen
    s_add_u32 s15, s15, 258048
    buffer_load_dwordx4 v[100:103], v38, s[52:55], s15 offen
    buffer_load_dwordx4 v[184:187], v38, s[60:63], s15 offen
    s_add_u32 s15, s15, 258048
    buffer_load_dwordx4 v[104:107], v38, s[52:55], s15 offen
    buffer_load_dwordx4 v[188:191], v38, s[60:63], s15 offen
    s_add_u32 s15, s15, 258048
    buffer_load_dwordx4 v[108:111], v38, s[52:55], s15 offen
    buffer_load_dwordx4 v[192:195], v38, s[60:63], s15 offen
    s_add_u32 s15, s15, 258048
    buffer_load_dwordx4 v[112:115], v38, s[52:55], s15 offen
    buffer_load_dwordx4 v[196:199], v38, s[60:63], s15 offen
    s_add_u32 s15, s15, 258048
    buffer_load_dwordx4 v[116:119], v38, s[52:55], s15 offen
    buffer_load_dwordx4 v[200:203], v38, s[60:63], s15 offen
    s_add_u32 s15, s15, 258048
    buffer_load_dwordx4 v[120:123], v38, s[52:55], s15 offen
    buffer_load_dwordx4 v[204:207], v38, s[60:63], s15 offen
    s_waitcnt vmcnt(42)
    v_lshlrev_b32 v22, 16, v16
    v_and_b32 v23, 0xffff0000, v16
    v_lshlrev_b32 v24, 16, v17
    v_and_b32 v25, 0xffff0000, v17
    v_lshlrev_b32 v26, 16, v18
    v_and_b32 v27, 0xffff0000, v18
    v_lshlrev_b32 v28, 16, v19
    v_and_b32 v29, 0xffff0000, v19
    v_lshlrev_b32 v30, 16, v20
    v_add_f32 v31, v22, v23
    v_add_f32 v31, v31, v24
    v_add_f32 v31, v31, v25
    v_add_f32 v31, v31, v26
    v_add_f32 v31, v31, v27
    v_add_f32 v31, v31, v28
    v_add_f32 v31, v31, v29
    v_add_f32 v31, v31, v30
    s_nop 1
    v_add_f32_dpp v31, v31, v31 row_ror:8 row_mask:0xf bank_mask:0xf
    s_nop 1
    v_add_f32_dpp v31, v31, v31 row_ror:4 row_mask:0xf bank_mask:0xf
    s_nop 1
    v_add_f32_dpp v31, v31, v31 row_ror:2 row_mask:0xf bank_mask:0xf
    s_nop 1
    v_add_f32_dpp v31, v31, v31 row_ror:1 row_mask:0xf bank_mask:0xf
    s_nop 1
    v_mov_b32 v32, v31
    s_nop 1
    v_permlane16_swap_b32 v31, v32
    s_nop 1
    v_add_f32 v31, v31, v32
    v_mov_b32 v32, v31
    s_nop 1
    v_permlane32_swap_b32 v31, v32
    s_nop 1
    v_add_f32 v31, v31, v32
    v_mul_f32 v31, 0x3ae38e39, v31
    v_sub_f32 v33, v22, v31
    v_mul_f32 v32, v33, v33
    v_sub_f32 v33, v23, v31
    v_fmac_f32 v32, v33, v33
    v_sub_f32 v33, v24, v31
    v_fmac_f32 v32, v33, v33
    v_sub_f32 v33, v25, v31
    v_fmac_f32 v32, v33, v33
    v_sub_f32 v33, v26, v31
    v_fmac_f32 v32, v33, v33
    v_sub_f32 v33, v27, v31
    v_fmac_f32 v32, v33, v33
    v_sub_f32 v33, v28, v31
    v_fmac_f32 v32, v33, v33
    v_sub_f32 v33, v29, v31
    v_fmac_f32 v32, v33, v33
    v_sub_f32 v33, v30, v31
    v_fmac_f32 v32, v33, v33
    s_nop 1
    v_add_f32_dpp v32, v32, v32 row_ror:8 row_mask:0xf bank_mask:0xf
    s_nop 1
    v_add_f32_dpp v32, v32, v32 row_ror:4 row_mask:0xf bank_mask:0xf
    s_nop 1
    v_add_f32_dpp v32, v32, v32 row_ror:2 row_mask:0xf bank_mask:0xf
    s_nop 1
    v_add_f32_dpp v32, v32, v32 row_ror:1 row_mask:0xf bank_mask:0xf
    s_nop 1
    v_mov_b32 v33, v32
    s_nop 1
    v_permlane16_swap_b32 v32, v33
    s_nop 1
    v_add_f32 v32, v32, v33
    v_mov_b32 v33, v32
    s_nop 1
    v_permlane32_swap_b32 v32, v33
    s_nop 1
    v_add_f32 v32, v32, v33
    v_mul_f32 v32, 0x3ae38e39, v32
    v_cvt_pk_bf16_f32 v32, v32, v32
    v_and_b32 v32, 0xffff0000, v32
    v_add_f32 v32, 0x3727c5ac, v32
    v_cvt_pk_bf16_f32 v32, v32, v32
    v_and_b32 v32, 0xffff0000, v32
    v_sqrt_f32 v32, v32
    s_nop 0
    v_cvt_pk_bf16_f32 v32, v32, v32
    v_and_b32 v32, 0xffff0000, v32
    v_rcp_f32 v33, v32
    v_cvt_pk_bf16_f32 v31, v31, v31
    v_and_b32 v31, 0xffff0000, v31
    v_sub_f32 v22, v22, v31
    v_cvt_pk_bf16_f32 v22, v22, v22
    v_and_b32 v22, 0xffff0000, v22
    v_mul_f32 v34, v22, v33
    v_fma_f32 v35, -v34, v32, v22
    v_fma_f32 v22, v35, v33, v34
    v_cvt_pk_bf16_f32 v22, v22, v22
    v_and_b32 v22, 0xffff0000, v22
    v_sub_f32 v23, v23, v31
    v_cvt_pk_bf16_f32 v23, v23, v23
    v_and_b32 v23, 0xffff0000, v23
    v_mul_f32 v34, v23, v33
    v_fma_f32 v35, -v34, v32, v23
    v_fma_f32 v23, v35, v33, v34
    v_cvt_pk_bf16_f32 v23, v23, v23
    v_and_b32 v23, 0xffff0000, v23
    v_sub_f32 v24, v24, v31
    v_cvt_pk_bf16_f32 v24, v24, v24
    v_and_b32 v24, 0xffff0000, v24
    v_mul_f32 v34, v24, v33
    v_fma_f32 v35, -v34, v32, v24
    v_fma_f32 v24, v35, v33, v34
    v_cvt_pk_bf16_f32 v24, v24, v24
    v_and_b32 v24, 0xffff0000, v24
    v_sub_f32 v25, v25, v31
    v_cvt_pk_bf16_f32 v25, v25, v25
    v_and_b32 v25, 0xffff0000, v25
    v_mul_f32 v34, v25, v33
    v_fma_f32 v35, -v34, v32, v25
    v_fma_f32 v25, v35, v33, v34
    v_cvt_pk_bf16_f32 v25, v25, v25
    v_and_b32 v25, 0xffff0000, v25
    v_sub_f32 v26, v26, v31
    v_cvt_pk_bf16_f32 v26, v26, v26
    v_and_b32 v26, 0xffff0000, v26
    v_mul_f32 v34, v26, v33
    v_fma_f32 v35, -v34, v32, v26
    v_fma_f32 v26, v35, v33, v34
    v_cvt_pk_bf16_f32 v26, v26, v26
    v_and_b32 v26, 0xffff0000, v26
    v_sub_f32 v27, v27, v31
    v_cvt_pk_bf16_f32 v27, v27, v27
    v_and_b32 v27, 0xffff0000, v27
    v_mul_f32 v34, v27, v33
    v_fma_f32 v35, -v34, v32, v27
    v_fma_f32 v27, v35, v33, v34
    v_cvt_pk_bf16_f32 v27, v27, v27
    v_and_b32 v27, 0xffff0000, v27
    v_sub_f32 v28, v28, v31
    v_cvt_pk_bf16_f32 v28, v28, v28
    v_and_b32 v28, 0xffff0000, v28
    v_mul_f32 v34, v28, v33
    v_fma_f32 v35, -v34, v32, v28
    v_fma_f32 v28, v35, v33, v34
    v_cvt_pk_bf16_f32 v28, v28, v28
    v_and_b32 v28, 0xffff0000, v28
    v_sub_f32 v29, v29, v31
    v_cvt_pk_bf16_f32 v29, v29, v29
    v_and_b32 v29, 0xffff0000, v29
    v_mul_f32 v34, v29, v33
    v_fma_f32 v35, -v34, v32, v29
    v_fma_f32 v29, v35, v33, v34
    v_cvt_pk_bf16_f32 v29, v29, v29
    v_and_b32 v29, 0xffff0000, v29
    v_sub_f32 v30, v30, v31
    v_cvt_pk_bf16_f32 v30, v30, v30
    v_and_b32 v30, 0xffff0000, v30
    v_mul_f32 v34, v30, v33
    v_fma_f32 v35, -v34, v32, v30
    v_fma_f32 v30, v35, v33, v34
    v_cvt_pk_bf16_f32 v30, v30, v30
    v_and_b32 v30, 0xffff0000, v30
    v_lshlrev_b32 v34, 5, v2
    ds_write_b128 v34, v[22:25] offset:0
    ds_write_b128 v34, v[26:29] offset:16
    v_lshlrev_b32 v34, 2, v2
    ds_write_b32 v34, v30 offset:2048
    v_and_b32 v34, 60, v34
    v_mov_b32 v35, 0
    ds_write_b32 v34, v35 offset:2304
    v_lshlrev_b32 v39, 2, v36
    ds_read_b32 v14, v39 offset:0
    ds_read_b32 v15, v39 offset:112
    ds_read_b32 v16, v39 offset:224
    ds_read_b32 v17, v39 offset:336
    ds_read_b32 v18, v39 offset:448
    ds_read_b32 v19, v39 offset:560
    ds_read_b32 v20, v39 offset:672
    ds_read_b32 v21, v39 offset:784
    ds_read_b32 v22, v39 offset:896
    ds_read_b32 v23, v39 offset:1008
    ds_read_b32 v24, v39 offset:1120
    ds_read_b32 v25, v39 offset:1232
    ds_read_b32 v26, v39 offset:1344
    ds_read_b32 v27, v39 offset:1456
    ds_read_b32 v28, v39 offset:1568
    ds_read_b32 v29, v39 offset:1680
    ds_read_b32 v30, v39 offset:1792
    ds_read_b32 v31, v39 offset:1904
    ds_read_b32 v32, v39 offset:2016
    ds_read_b32 v33, v39 offset:2128
    ds_read_b32 v34, v39 offset:2240
    v_mov_b32 v6, 0
    v_mov_b32 v208, 0
    v_mov_b32 v7, 0
    v_mov_b32 v209, 0
    v_mov_b32 v8, 0
    v_mov_b32 v210, 0
    v_mov_b32 v9, 0
    v_mov_b32 v211, 0
    v_mov_b32 v10, 0
    v_mov_b32 v212, 0
    v_mov_b32 v11, 0
    v_mov_b32 v213, 0
    v_mov_b32 v12, 0
    v_mov_b32 v214, 0
    v_mov_b32 v13, 0
    v_mov_b32 v215, 0
    s_waitcnt lgkmcnt(0)
    s_waitcnt vmcnt(40)
    v_lshlrev_b32 v35, 16, v40
    v_and_b32 v40, 0xffff0000, v40
    v_fmac_f32 v6, v14, v35
    v_fmac_f32 v7, v14, v40
    v_lshlrev_b32 v35, 16, v41
    v_and_b32 v41, 0xffff0000, v41
    v_fmac_f32 v8, v14, v35
    v_fmac_f32 v9, v14, v41
    v_lshlrev_b32 v35, 16, v42
    v_and_b32 v42, 0xffff0000, v42
    v_fmac_f32 v10, v14, v35
    v_fmac_f32 v11, v14, v42
    v_lshlrev_b32 v35, 16, v43
    v_and_b32 v43, 0xffff0000, v43
    v_fmac_f32 v12, v14, v35
    v_fmac_f32 v13, v14, v43
    v_lshlrev_b32 v35, 16, v124
    v_and_b32 v124, 0xffff0000, v124
    v_fmac_f32 v208, v14, v35
    v_fmac_f32 v209, v14, v124
    v_lshlrev_b32 v35, 16, v125
    v_and_b32 v125, 0xffff0000, v125
    v_fmac_f32 v210, v14, v35
    v_fmac_f32 v211, v14, v125
    v_lshlrev_b32 v35, 16, v126
    v_and_b32 v126, 0xffff0000, v126
    v_fmac_f32 v212, v14, v35
    v_fmac_f32 v213, v14, v126
    v_lshlrev_b32 v35, 16, v127
    v_and_b32 v127, 0xffff0000, v127
    v_fmac_f32 v214, v14, v35
    v_fmac_f32 v215, v14, v127
    s_waitcnt vmcnt(38)
    v_lshlrev_b32 v35, 16, v44
    v_and_b32 v44, 0xffff0000, v44
    v_fmac_f32 v6, v15, v35
    v_fmac_f32 v7, v15, v44
    v_lshlrev_b32 v35, 16, v45
    v_and_b32 v45, 0xffff0000, v45
    v_fmac_f32 v8, v15, v35
    v_fmac_f32 v9, v15, v45
    v_lshlrev_b32 v35, 16, v46
    v_and_b32 v46, 0xffff0000, v46
    v_fmac_f32 v10, v15, v35
    v_fmac_f32 v11, v15, v46
    v_lshlrev_b32 v35, 16, v47
    v_and_b32 v47, 0xffff0000, v47
    v_fmac_f32 v12, v15, v35
    v_fmac_f32 v13, v15, v47
    v_lshlrev_b32 v35, 16, v128
    v_and_b32 v128, 0xffff0000, v128
    v_fmac_f32 v208, v15, v35
    v_fmac_f32 v209, v15, v128
    v_lshlrev_b32 v35, 16, v129
    v_and_b32 v129, 0xffff0000, v129
    v_fmac_f32 v210, v15, v35
    v_fmac_f32 v211, v15, v129
    v_lshlrev_b32 v35, 16, v130
    v_and_b32 v130, 0xffff0000, v130
    v_fmac_f32 v212, v15, v35
    v_fmac_f32 v213, v15, v130
    v_lshlrev_b32 v35, 16, v131
    v_and_b32 v131, 0xffff0000, v131
    v_fmac_f32 v214, v15, v35
    v_fmac_f32 v215, v15, v131
    s_waitcnt vmcnt(36)
    v_lshlrev_b32 v35, 16, v48
    v_and_b32 v48, 0xffff0000, v48
    v_fmac_f32 v6, v16, v35
    v_fmac_f32 v7, v16, v48
    v_lshlrev_b32 v35, 16, v49
    v_and_b32 v49, 0xffff0000, v49
    v_fmac_f32 v8, v16, v35
    v_fmac_f32 v9, v16, v49
    v_lshlrev_b32 v35, 16, v50
    v_and_b32 v50, 0xffff0000, v50
    v_fmac_f32 v10, v16, v35
    v_fmac_f32 v11, v16, v50
    v_lshlrev_b32 v35, 16, v51
    v_and_b32 v51, 0xffff0000, v51
    v_fmac_f32 v12, v16, v35
    v_fmac_f32 v13, v16, v51
    v_lshlrev_b32 v35, 16, v132
    v_and_b32 v132, 0xffff0000, v132
    v_fmac_f32 v208, v16, v35
    v_fmac_f32 v209, v16, v132
    v_lshlrev_b32 v35, 16, v133
    v_and_b32 v133, 0xffff0000, v133
    v_fmac_f32 v210, v16, v35
    v_fmac_f32 v211, v16, v133
    v_lshlrev_b32 v35, 16, v134
    v_and_b32 v134, 0xffff0000, v134
    v_fmac_f32 v212, v16, v35
    v_fmac_f32 v213, v16, v134
    v_lshlrev_b32 v35, 16, v135
    v_and_b32 v135, 0xffff0000, v135
    v_fmac_f32 v214, v16, v35
    v_fmac_f32 v215, v16, v135
    s_waitcnt vmcnt(34)
    v_lshlrev_b32 v35, 16, v52
    v_and_b32 v52, 0xffff0000, v52
    v_fmac_f32 v6, v17, v35
    v_fmac_f32 v7, v17, v52
    v_lshlrev_b32 v35, 16, v53
    v_and_b32 v53, 0xffff0000, v53
    v_fmac_f32 v8, v17, v35
    v_fmac_f32 v9, v17, v53
    v_lshlrev_b32 v35, 16, v54
    v_and_b32 v54, 0xffff0000, v54
    v_fmac_f32 v10, v17, v35
    v_fmac_f32 v11, v17, v54
    v_lshlrev_b32 v35, 16, v55
    v_and_b32 v55, 0xffff0000, v55
    v_fmac_f32 v12, v17, v35
    v_fmac_f32 v13, v17, v55
    v_lshlrev_b32 v35, 16, v136
    v_and_b32 v136, 0xffff0000, v136
    v_fmac_f32 v208, v17, v35
    v_fmac_f32 v209, v17, v136
    v_lshlrev_b32 v35, 16, v137
    v_and_b32 v137, 0xffff0000, v137
    v_fmac_f32 v210, v17, v35
    v_fmac_f32 v211, v17, v137
    v_lshlrev_b32 v35, 16, v138
    v_and_b32 v138, 0xffff0000, v138
    v_fmac_f32 v212, v17, v35
    v_fmac_f32 v213, v17, v138
    v_lshlrev_b32 v35, 16, v139
    v_and_b32 v139, 0xffff0000, v139
    v_fmac_f32 v214, v17, v35
    v_fmac_f32 v215, v17, v139
    s_waitcnt vmcnt(32)
    v_lshlrev_b32 v35, 16, v56
    v_and_b32 v56, 0xffff0000, v56
    v_fmac_f32 v6, v18, v35
    v_fmac_f32 v7, v18, v56
    v_lshlrev_b32 v35, 16, v57
    v_and_b32 v57, 0xffff0000, v57
    v_fmac_f32 v8, v18, v35
    v_fmac_f32 v9, v18, v57
    v_lshlrev_b32 v35, 16, v58
    v_and_b32 v58, 0xffff0000, v58
    v_fmac_f32 v10, v18, v35
    v_fmac_f32 v11, v18, v58
    v_lshlrev_b32 v35, 16, v59
    v_and_b32 v59, 0xffff0000, v59
    v_fmac_f32 v12, v18, v35
    v_fmac_f32 v13, v18, v59
    v_lshlrev_b32 v35, 16, v140
    v_and_b32 v140, 0xffff0000, v140
    v_fmac_f32 v208, v18, v35
    v_fmac_f32 v209, v18, v140
    v_lshlrev_b32 v35, 16, v141
    v_and_b32 v141, 0xffff0000, v141
    v_fmac_f32 v210, v18, v35
    v_fmac_f32 v211, v18, v141
    v_lshlrev_b32 v35, 16, v142
    v_and_b32 v142, 0xffff0000, v142
    v_fmac_f32 v212, v18, v35
    v_fmac_f32 v213, v18, v142
    v_lshlrev_b32 v35, 16, v143
    v_and_b32 v143, 0xffff0000, v143
    v_fmac_f32 v214, v18, v35
    v_fmac_f32 v215, v18, v143
    s_waitcnt vmcnt(30)
    v_lshlrev_b32 v35, 16, v60
    v_and_b32 v60, 0xffff0000, v60
    v_fmac_f32 v6, v19, v35
    v_fmac_f32 v7, v19, v60
    v_lshlrev_b32 v35, 16, v61
    v_and_b32 v61, 0xffff0000, v61
    v_fmac_f32 v8, v19, v35
    v_fmac_f32 v9, v19, v61
    v_lshlrev_b32 v35, 16, v62
    v_and_b32 v62, 0xffff0000, v62
    v_fmac_f32 v10, v19, v35
    v_fmac_f32 v11, v19, v62
    v_lshlrev_b32 v35, 16, v63
    v_and_b32 v63, 0xffff0000, v63
    v_fmac_f32 v12, v19, v35
    v_fmac_f32 v13, v19, v63
    v_lshlrev_b32 v35, 16, v144
    v_and_b32 v144, 0xffff0000, v144
    v_fmac_f32 v208, v19, v35
    v_fmac_f32 v209, v19, v144
    v_lshlrev_b32 v35, 16, v145
    v_and_b32 v145, 0xffff0000, v145
    v_fmac_f32 v210, v19, v35
    v_fmac_f32 v211, v19, v145
    v_lshlrev_b32 v35, 16, v146
    v_and_b32 v146, 0xffff0000, v146
    v_fmac_f32 v212, v19, v35
    v_fmac_f32 v213, v19, v146
    v_lshlrev_b32 v35, 16, v147
    v_and_b32 v147, 0xffff0000, v147
    v_fmac_f32 v214, v19, v35
    v_fmac_f32 v215, v19, v147
    s_waitcnt vmcnt(28)
    v_lshlrev_b32 v35, 16, v64
    v_and_b32 v64, 0xffff0000, v64
    v_fmac_f32 v6, v20, v35
    v_fmac_f32 v7, v20, v64
    v_lshlrev_b32 v35, 16, v65
    v_and_b32 v65, 0xffff0000, v65
    v_fmac_f32 v8, v20, v35
    v_fmac_f32 v9, v20, v65
    v_lshlrev_b32 v35, 16, v66
    v_and_b32 v66, 0xffff0000, v66
    v_fmac_f32 v10, v20, v35
    v_fmac_f32 v11, v20, v66
    v_lshlrev_b32 v35, 16, v67
    v_and_b32 v67, 0xffff0000, v67
    v_fmac_f32 v12, v20, v35
    v_fmac_f32 v13, v20, v67
    v_lshlrev_b32 v35, 16, v148
    v_and_b32 v148, 0xffff0000, v148
    v_fmac_f32 v208, v20, v35
    v_fmac_f32 v209, v20, v148
    v_lshlrev_b32 v35, 16, v149
    v_and_b32 v149, 0xffff0000, v149
    v_fmac_f32 v210, v20, v35
    v_fmac_f32 v211, v20, v149
    v_lshlrev_b32 v35, 16, v150
    v_and_b32 v150, 0xffff0000, v150
    v_fmac_f32 v212, v20, v35
    v_fmac_f32 v213, v20, v150
    v_lshlrev_b32 v35, 16, v151
    v_and_b32 v151, 0xffff0000, v151
    v_fmac_f32 v214, v20, v35
    v_fmac_f32 v215, v20, v151
    s_waitcnt vmcnt(26)
    v_lshlrev_b32 v35, 16, v68
    v_and_b32 v68, 0xffff0000, v68
    v_fmac_f32 v6, v21, v35
    v_fmac_f32 v7, v21, v68
    v_lshlrev_b32 v35, 16, v69
    v_and_b32 v69, 0xffff0000, v69
    v_fmac_f32 v8, v21, v35
    v_fmac_f32 v9, v21, v69
    v_lshlrev_b32 v35, 16, v70
    v_and_b32 v70, 0xffff0000, v70
    v_fmac_f32 v10, v21, v35
    v_fmac_f32 v11, v21, v70
    v_lshlrev_b32 v35, 16, v71
    v_and_b32 v71, 0xffff0000, v71
    v_fmac_f32 v12, v21, v35
    v_fmac_f32 v13, v21, v71
    v_lshlrev_b32 v35, 16, v152
    v_and_b32 v152, 0xffff0000, v152
    v_fmac_f32 v208, v21, v35
    v_fmac_f32 v209, v21, v152
    v_lshlrev_b32 v35, 16, v153
    v_and_b32 v153, 0xffff0000, v153
    v_fmac_f32 v210, v21, v35
    v_fmac_f32 v211, v21, v153
    v_lshlrev_b32 v35, 16, v154
    v_and_b32 v154, 0xffff0000, v154
    v_fmac_f32 v212, v21, v35
    v_fmac_f32 v213, v21, v154
    v_lshlrev_b32 v35, 16, v155
    v_and_b32 v155, 0xffff0000, v155
    v_fmac_f32 v214, v21, v35
    v_fmac_f32 v215, v21, v155
    s_waitcnt vmcnt(24)
    v_lshlrev_b32 v35, 16, v72
    v_and_b32 v72, 0xffff0000, v72
    v_fmac_f32 v6, v22, v35
    v_fmac_f32 v7, v22, v72
    v_lshlrev_b32 v35, 16, v73
    v_and_b32 v73, 0xffff0000, v73
    v_fmac_f32 v8, v22, v35
    v_fmac_f32 v9, v22, v73
    v_lshlrev_b32 v35, 16, v74
    v_and_b32 v74, 0xffff0000, v74
    v_fmac_f32 v10, v22, v35
    v_fmac_f32 v11, v22, v74
    v_lshlrev_b32 v35, 16, v75
    v_and_b32 v75, 0xffff0000, v75
    v_fmac_f32 v12, v22, v35
    v_fmac_f32 v13, v22, v75
    v_lshlrev_b32 v35, 16, v156
    v_and_b32 v156, 0xffff0000, v156
    v_fmac_f32 v208, v22, v35
    v_fmac_f32 v209, v22, v156
    v_lshlrev_b32 v35, 16, v157
    v_and_b32 v157, 0xffff0000, v157
    v_fmac_f32 v210, v22, v35
    v_fmac_f32 v211, v22, v157
    v_lshlrev_b32 v35, 16, v158
    v_and_b32 v158, 0xffff0000, v158
    v_fmac_f32 v212, v22, v35
    v_fmac_f32 v213, v22, v158
    v_lshlrev_b32 v35, 16, v159
    v_and_b32 v159, 0xffff0000, v159
    v_fmac_f32 v214, v22, v35
    v_fmac_f32 v215, v22, v159
    s_waitcnt vmcnt(22)
    v_lshlrev_b32 v35, 16, v76
    v_and_b32 v76, 0xffff0000, v76
    v_fmac_f32 v6, v23, v35
    v_fmac_f32 v7, v23, v76
    v_lshlrev_b32 v35, 16, v77
    v_and_b32 v77, 0xffff0000, v77
    v_fmac_f32 v8, v23, v35
    v_fmac_f32 v9, v23, v77
    v_lshlrev_b32 v35, 16, v78
    v_and_b32 v78, 0xffff0000, v78
    v_fmac_f32 v10, v23, v35
    v_fmac_f32 v11, v23, v78
    v_lshlrev_b32 v35, 16, v79
    v_and_b32 v79, 0xffff0000, v79
    v_fmac_f32 v12, v23, v35
    v_fmac_f32 v13, v23, v79
    v_lshlrev_b32 v35, 16, v160
    v_and_b32 v160, 0xffff0000, v160
    v_fmac_f32 v208, v23, v35
    v_fmac_f32 v209, v23, v160
    v_lshlrev_b32 v35, 16, v161
    v_and_b32 v161, 0xffff0000, v161
    v_fmac_f32 v210, v23, v35
    v_fmac_f32 v211, v23, v161
    v_lshlrev_b32 v35, 16, v162
    v_and_b32 v162, 0xffff0000, v162
    v_fmac_f32 v212, v23, v35
    v_fmac_f32 v213, v23, v162
    v_lshlrev_b32 v35, 16, v163
    v_and_b32 v163, 0xffff0000, v163
    v_fmac_f32 v214, v23, v35
    v_fmac_f32 v215, v23, v163
    s_waitcnt vmcnt(20)
    v_lshlrev_b32 v35, 16, v80
    v_and_b32 v80, 0xffff0000, v80
    v_fmac_f32 v6, v24, v35
    v_fmac_f32 v7, v24, v80
    v_lshlrev_b32 v35, 16, v81
    v_and_b32 v81, 0xffff0000, v81
    v_fmac_f32 v8, v24, v35
    v_fmac_f32 v9, v24, v81
    v_lshlrev_b32 v35, 16, v82
    v_and_b32 v82, 0xffff0000, v82
    v_fmac_f32 v10, v24, v35
    v_fmac_f32 v11, v24, v82
    v_lshlrev_b32 v35, 16, v83
    v_and_b32 v83, 0xffff0000, v83
    v_fmac_f32 v12, v24, v35
    v_fmac_f32 v13, v24, v83
    v_lshlrev_b32 v35, 16, v164
    v_and_b32 v164, 0xffff0000, v164
    v_fmac_f32 v208, v24, v35
    v_fmac_f32 v209, v24, v164
    v_lshlrev_b32 v35, 16, v165
    v_and_b32 v165, 0xffff0000, v165
    v_fmac_f32 v210, v24, v35
    v_fmac_f32 v211, v24, v165
    v_lshlrev_b32 v35, 16, v166
    v_and_b32 v166, 0xffff0000, v166
    v_fmac_f32 v212, v24, v35
    v_fmac_f32 v213, v24, v166
    v_lshlrev_b32 v35, 16, v167
    v_and_b32 v167, 0xffff0000, v167
    v_fmac_f32 v214, v24, v35
    v_fmac_f32 v215, v24, v167
    s_waitcnt vmcnt(18)
    v_lshlrev_b32 v35, 16, v84
    v_and_b32 v84, 0xffff0000, v84
    v_fmac_f32 v6, v25, v35
    v_fmac_f32 v7, v25, v84
    v_lshlrev_b32 v35, 16, v85
    v_and_b32 v85, 0xffff0000, v85
    v_fmac_f32 v8, v25, v35
    v_fmac_f32 v9, v25, v85
    v_lshlrev_b32 v35, 16, v86
    v_and_b32 v86, 0xffff0000, v86
    v_fmac_f32 v10, v25, v35
    v_fmac_f32 v11, v25, v86
    v_lshlrev_b32 v35, 16, v87
    v_and_b32 v87, 0xffff0000, v87
    v_fmac_f32 v12, v25, v35
    v_fmac_f32 v13, v25, v87
    v_lshlrev_b32 v35, 16, v168
    v_and_b32 v168, 0xffff0000, v168
    v_fmac_f32 v208, v25, v35
    v_fmac_f32 v209, v25, v168
    v_lshlrev_b32 v35, 16, v169
    v_and_b32 v169, 0xffff0000, v169
    v_fmac_f32 v210, v25, v35
    v_fmac_f32 v211, v25, v169
    v_lshlrev_b32 v35, 16, v170
    v_and_b32 v170, 0xffff0000, v170
    v_fmac_f32 v212, v25, v35
    v_fmac_f32 v213, v25, v170
    v_lshlrev_b32 v35, 16, v171
    v_and_b32 v171, 0xffff0000, v171
    v_fmac_f32 v214, v25, v35
    v_fmac_f32 v215, v25, v171
    s_waitcnt vmcnt(16)
    v_lshlrev_b32 v35, 16, v88
    v_and_b32 v88, 0xffff0000, v88
    v_fmac_f32 v6, v26, v35
    v_fmac_f32 v7, v26, v88
    v_lshlrev_b32 v35, 16, v89
    v_and_b32 v89, 0xffff0000, v89
    v_fmac_f32 v8, v26, v35
    v_fmac_f32 v9, v26, v89
    v_lshlrev_b32 v35, 16, v90
    v_and_b32 v90, 0xffff0000, v90
    v_fmac_f32 v10, v26, v35
    v_fmac_f32 v11, v26, v90
    v_lshlrev_b32 v35, 16, v91
    v_and_b32 v91, 0xffff0000, v91
    v_fmac_f32 v12, v26, v35
    v_fmac_f32 v13, v26, v91
    v_lshlrev_b32 v35, 16, v172
    v_and_b32 v172, 0xffff0000, v172
    v_fmac_f32 v208, v26, v35
    v_fmac_f32 v209, v26, v172
    v_lshlrev_b32 v35, 16, v173
    v_and_b32 v173, 0xffff0000, v173
    v_fmac_f32 v210, v26, v35
    v_fmac_f32 v211, v26, v173
    v_lshlrev_b32 v35, 16, v174
    v_and_b32 v174, 0xffff0000, v174
    v_fmac_f32 v212, v26, v35
    v_fmac_f32 v213, v26, v174
    v_lshlrev_b32 v35, 16, v175
    v_and_b32 v175, 0xffff0000, v175
    v_fmac_f32 v214, v26, v35
    v_fmac_f32 v215, v26, v175
    s_waitcnt vmcnt(14)
    v_lshlrev_b32 v35, 16, v92
    v_and_b32 v92, 0xffff0000, v92
    v_fmac_f32 v6, v27, v35
    v_fmac_f32 v7, v27, v92
    v_lshlrev_b32 v35, 16, v93
    v_and_b32 v93, 0xffff0000, v93
    v_fmac_f32 v8, v27, v35
    v_fmac_f32 v9, v27, v93
    v_lshlrev_b32 v35, 16, v94
    v_and_b32 v94, 0xffff0000, v94
    v_fmac_f32 v10, v27, v35
    v_fmac_f32 v11, v27, v94
    v_lshlrev_b32 v35, 16, v95
    v_and_b32 v95, 0xffff0000, v95
    v_fmac_f32 v12, v27, v35
    v_fmac_f32 v13, v27, v95
    v_lshlrev_b32 v35, 16, v176
    v_and_b32 v176, 0xffff0000, v176
    v_fmac_f32 v208, v27, v35
    v_fmac_f32 v209, v27, v176
    v_lshlrev_b32 v35, 16, v177
    v_and_b32 v177, 0xffff0000, v177
    v_fmac_f32 v210, v27, v35
    v_fmac_f32 v211, v27, v177
    v_lshlrev_b32 v35, 16, v178
    v_and_b32 v178, 0xffff0000, v178
    v_fmac_f32 v212, v27, v35
    v_fmac_f32 v213, v27, v178
    v_lshlrev_b32 v35, 16, v179
    v_and_b32 v179, 0xffff0000, v179
    v_fmac_f32 v214, v27, v35
    v_fmac_f32 v215, v27, v179
    s_waitcnt vmcnt(12)
    v_lshlrev_b32 v35, 16, v96
    v_and_b32 v96, 0xffff0000, v96
    v_fmac_f32 v6, v28, v35
    v_fmac_f32 v7, v28, v96
    v_lshlrev_b32 v35, 16, v97
    v_and_b32 v97, 0xffff0000, v97
    v_fmac_f32 v8, v28, v35
    v_fmac_f32 v9, v28, v97
    v_lshlrev_b32 v35, 16, v98
    v_and_b32 v98, 0xffff0000, v98
    v_fmac_f32 v10, v28, v35
    v_fmac_f32 v11, v28, v98
    v_lshlrev_b32 v35, 16, v99
    v_and_b32 v99, 0xffff0000, v99
    v_fmac_f32 v12, v28, v35
    v_fmac_f32 v13, v28, v99
    v_lshlrev_b32 v35, 16, v180
    v_and_b32 v180, 0xffff0000, v180
    v_fmac_f32 v208, v28, v35
    v_fmac_f32 v209, v28, v180
    v_lshlrev_b32 v35, 16, v181
    v_and_b32 v181, 0xffff0000, v181
    v_fmac_f32 v210, v28, v35
    v_fmac_f32 v211, v28, v181
    v_lshlrev_b32 v35, 16, v182
    v_and_b32 v182, 0xffff0000, v182
    v_fmac_f32 v212, v28, v35
    v_fmac_f32 v213, v28, v182
    v_lshlrev_b32 v35, 16, v183
    v_and_b32 v183, 0xffff0000, v183
    v_fmac_f32 v214, v28, v35
    v_fmac_f32 v215, v28, v183
    s_waitcnt vmcnt(10)
    v_lshlrev_b32 v35, 16, v100
    v_and_b32 v100, 0xffff0000, v100
    v_fmac_f32 v6, v29, v35
    v_fmac_f32 v7, v29, v100
    v_lshlrev_b32 v35, 16, v101
    v_and_b32 v101, 0xffff0000, v101
    v_fmac_f32 v8, v29, v35
    v_fmac_f32 v9, v29, v101
    v_lshlrev_b32 v35, 16, v102
    v_and_b32 v102, 0xffff0000, v102
    v_fmac_f32 v10, v29, v35
    v_fmac_f32 v11, v29, v102
    v_lshlrev_b32 v35, 16, v103
    v_and_b32 v103, 0xffff0000, v103
    v_fmac_f32 v12, v29, v35
    v_fmac_f32 v13, v29, v103
    v_lshlrev_b32 v35, 16, v184
    v_and_b32 v184, 0xffff0000, v184
    v_fmac_f32 v208, v29, v35
    v_fmac_f32 v209, v29, v184
    v_lshlrev_b32 v35, 16, v185
    v_and_b32 v185, 0xffff0000, v185
    v_fmac_f32 v210, v29, v35
    v_fmac_f32 v211, v29, v185
    v_lshlrev_b32 v35, 16, v186
    v_and_b32 v186, 0xffff0000, v186
    v_fmac_f32 v212, v29, v35
    v_fmac_f32 v213, v29, v186
    v_lshlrev_b32 v35, 16, v187
    v_and_b32 v187, 0xffff0000, v187
    v_fmac_f32 v214, v29, v35
    v_fmac_f32 v215, v29, v187
    s_waitcnt vmcnt(8)
    v_lshlrev_b32 v35, 16, v104
    v_and_b32 v104, 0xffff0000, v104
    v_fmac_f32 v6, v30, v35
    v_fmac_f32 v7, v30, v104
    v_lshlrev_b32 v35, 16, v105
    v_and_b32 v105, 0xffff0000, v105
    v_fmac_f32 v8, v30, v35
    v_fmac_f32 v9, v30, v105
    v_lshlrev_b32 v35, 16, v106
    v_and_b32 v106, 0xffff0000, v106
    v_fmac_f32 v10, v30, v35
    v_fmac_f32 v11, v30, v106
    v_lshlrev_b32 v35, 16, v107
    v_and_b32 v107, 0xffff0000, v107
    v_fmac_f32 v12, v30, v35
    v_fmac_f32 v13, v30, v107
    v_lshlrev_b32 v35, 16, v188
    v_and_b32 v188, 0xffff0000, v188
    v_fmac_f32 v208, v30, v35
    v_fmac_f32 v209, v30, v188
    v_lshlrev_b32 v35, 16, v189
    v_and_b32 v189, 0xffff0000, v189
    v_fmac_f32 v210, v30, v35
    v_fmac_f32 v211, v30, v189
    v_lshlrev_b32 v35, 16, v190
    v_and_b32 v190, 0xffff0000, v190
    v_fmac_f32 v212, v30, v35
    v_fmac_f32 v213, v30, v190
    v_lshlrev_b32 v35, 16, v191
    v_and_b32 v191, 0xffff0000, v191
    v_fmac_f32 v214, v30, v35
    v_fmac_f32 v215, v30, v191
    s_waitcnt vmcnt(6)
    v_lshlrev_b32 v35, 16, v108
    v_and_b32 v108, 0xffff0000, v108
    v_fmac_f32 v6, v31, v35
    v_fmac_f32 v7, v31, v108
    v_lshlrev_b32 v35, 16, v109
    v_and_b32 v109, 0xffff0000, v109
    v_fmac_f32 v8, v31, v35
    v_fmac_f32 v9, v31, v109
    v_lshlrev_b32 v35, 16, v110
    v_and_b32 v110, 0xffff0000, v110
    v_fmac_f32 v10, v31, v35
    v_fmac_f32 v11, v31, v110
    v_lshlrev_b32 v35, 16, v111
    v_and_b32 v111, 0xffff0000, v111
    v_fmac_f32 v12, v31, v35
    v_fmac_f32 v13, v31, v111
    v_lshlrev_b32 v35, 16, v192
    v_and_b32 v192, 0xffff0000, v192
    v_fmac_f32 v208, v31, v35
    v_fmac_f32 v209, v31, v192
    v_lshlrev_b32 v35, 16, v193
    v_and_b32 v193, 0xffff0000, v193
    v_fmac_f32 v210, v31, v35
    v_fmac_f32 v211, v31, v193
    v_lshlrev_b32 v35, 16, v194
    v_and_b32 v194, 0xffff0000, v194
    v_fmac_f32 v212, v31, v35
    v_fmac_f32 v213, v31, v194
    v_lshlrev_b32 v35, 16, v195
    v_and_b32 v195, 0xffff0000, v195
    v_fmac_f32 v214, v31, v35
    v_fmac_f32 v215, v31, v195
    s_waitcnt vmcnt(4)
    v_lshlrev_b32 v35, 16, v112
    v_and_b32 v112, 0xffff0000, v112
    v_fmac_f32 v6, v32, v35
    v_fmac_f32 v7, v32, v112
    v_lshlrev_b32 v35, 16, v113
    v_and_b32 v113, 0xffff0000, v113
    v_fmac_f32 v8, v32, v35
    v_fmac_f32 v9, v32, v113
    v_lshlrev_b32 v35, 16, v114
    v_and_b32 v114, 0xffff0000, v114
    v_fmac_f32 v10, v32, v35
    v_fmac_f32 v11, v32, v114
    v_lshlrev_b32 v35, 16, v115
    v_and_b32 v115, 0xffff0000, v115
    v_fmac_f32 v12, v32, v35
    v_fmac_f32 v13, v32, v115
    v_lshlrev_b32 v35, 16, v196
    v_and_b32 v196, 0xffff0000, v196
    v_fmac_f32 v208, v32, v35
    v_fmac_f32 v209, v32, v196
    v_lshlrev_b32 v35, 16, v197
    v_and_b32 v197, 0xffff0000, v197
    v_fmac_f32 v210, v32, v35
    v_fmac_f32 v211, v32, v197
    v_lshlrev_b32 v35, 16, v198
    v_and_b32 v198, 0xffff0000, v198
    v_fmac_f32 v212, v32, v35
    v_fmac_f32 v213, v32, v198
    v_lshlrev_b32 v35, 16, v199
    v_and_b32 v199, 0xffff0000, v199
    v_fmac_f32 v214, v32, v35
    v_fmac_f32 v215, v32, v199
    s_waitcnt vmcnt(2)
    v_lshlrev_b32 v35, 16, v116
    v_and_b32 v116, 0xffff0000, v116
    v_fmac_f32 v6, v33, v35
    v_fmac_f32 v7, v33, v116
    v_lshlrev_b32 v35, 16, v117
    v_and_b32 v117, 0xffff0000, v117
    v_fmac_f32 v8, v33, v35
    v_fmac_f32 v9, v33, v117
    v_lshlrev_b32 v35, 16, v118
    v_and_b32 v118, 0xffff0000, v118
    v_fmac_f32 v10, v33, v35
    v_fmac_f32 v11, v33, v118
    v_lshlrev_b32 v35, 16, v119
    v_and_b32 v119, 0xffff0000, v119
    v_fmac_f32 v12, v33, v35
    v_fmac_f32 v13, v33, v119
    v_lshlrev_b32 v35, 16, v200
    v_and_b32 v200, 0xffff0000, v200
    v_fmac_f32 v208, v33, v35
    v_fmac_f32 v209, v33, v200
    v_lshlrev_b32 v35, 16, v201
    v_and_b32 v201, 0xffff0000, v201
    v_fmac_f32 v210, v33, v35
    v_fmac_f32 v211, v33, v201
    v_lshlrev_b32 v35, 16, v202
    v_and_b32 v202, 0xffff0000, v202
    v_fmac_f32 v212, v33, v35
    v_fmac_f32 v213, v33, v202
    v_lshlrev_b32 v35, 16, v203
    v_and_b32 v203, 0xffff0000, v203
    v_fmac_f32 v214, v33, v35
    v_fmac_f32 v215, v33, v203
    s_waitcnt vmcnt(0)
    v_lshlrev_b32 v35, 16, v120
    v_and_b32 v120, 0xffff0000, v120
    v_fmac_f32 v6, v34, v35
    v_fmac_f32 v7, v34, v120
    v_lshlrev_b32 v35, 16, v121
    v_and_b32 v121, 0xffff0000, v121
    v_fmac_f32 v8, v34, v35
    v_fmac_f32 v9, v34, v121
    v_lshlrev_b32 v35, 16, v122
    v_and_b32 v122, 0xffff0000, v122
    v_fmac_f32 v10, v34, v35
    v_fmac_f32 v11, v34, v122
    v_lshlrev_b32 v35, 16, v123
    v_and_b32 v123, 0xffff0000, v123
    v_fmac_f32 v12, v34, v35
    v_fmac_f32 v13, v34, v123
    v_lshlrev_b32 v35, 16, v204
    v_and_b32 v204, 0xffff0000, v204
    v_fmac_f32 v208, v34, v35
    v_fmac_f32 v209, v34, v204
    v_lshlrev_b32 v35, 16, v205
    v_and_b32 v205, 0xffff0000, v205
    v_fmac_f32 v210, v34, v35
    v_fmac_f32 v211, v34, v205
    v_lshlrev_b32 v35, 16, v206
    v_and_b32 v206, 0xffff0000, v206
    v_fmac_f32 v212, v34, v35
    v_fmac_f32 v213, v34, v206
    v_lshlrev_b32 v35, 16, v207
    v_and_b32 v207, 0xffff0000, v207
    v_fmac_f32 v214, v34, v35
    v_fmac_f32 v215, v34, v207
    v_mul_u32_u24 v39, 576, v36
    v_lshl_add_u32 v39, v37, 5, v39
    ds_write_b128 v39, v[6:9] offset:2560
    ds_write_b128 v39, v[10:13] offset:2576
    ds_write_b128 v39, v[208:211] offset:19264
    ds_write_b128 v39, v[212:215] offset:19280
    v_mul_u32_u24 v37, 911, v0
    v_lshrrev_b32 v37, 16, v37
    v_mul_u32_u24 v38, 72, v37
    v_sub_u32 v38, v0, v38
    v_lshlrev_b32 v39, 4, v0
    v_cmp_gt_u32 vcc, 504, v0
    v_mov_b32 v35, 0x80000000
    s_nop 1
    v_cndmask_b32 v39, v35, v39, vcc
    s_mul_i32 s15, s8, 165888
    buffer_load_dwordx4 v[40:43], v39, s[56:59], s15 offen
    s_add_u32 s15, s15, 8064
    buffer_load_dwordx4 v[44:47], v39, s[56:59], s15 offen
    s_add_u32 s15, s15, 8064
    buffer_load_dwordx4 v[48:51], v39, s[56:59], s15 offen
    s_add_u32 s15, s15, 8064
    buffer_load_dwordx4 v[52:55], v39, s[56:59], s15 offen
    s_add_u32 s15, s15, 8064
    buffer_load_dwordx4 v[56:59], v39, s[56:59], s15 offen
    s_add_u32 s15, s15, 8064
    buffer_load_dwordx4 v[60:63], v39, s[56:59], s15 offen
    s_add_u32 s15, s15, 8064
    buffer_load_dwordx4 v[64:67], v39, s[56:59], s15 offen
    s_add_u32 s15, s15, 8064
    buffer_load_dwordx4 v[68:71], v39, s[56:59], s15 offen
    s_add_u32 s15, s15, 8064
    buffer_load_dwordx4 v[72:75], v39, s[56:59], s15 offen
    s_add_u32 s15, s15, 8064
    buffer_load_dwordx4 v[76:79], v39, s[56:59], s15 offen
    s_add_u32 s15, s15, 8064
    buffer_load_dwordx4 v[80:83], v39, s[56:59], s15 offen
    s_add_u32 s15, s15, 8064
    buffer_load_dwordx4 v[84:87], v39, s[56:59], s15 offen
    s_add_u32 s15, s15, 8064
    buffer_load_dwordx4 v[88:91], v39, s[56:59], s15 offen
    s_add_u32 s15, s15, 8064
    buffer_load_dwordx4 v[92:95], v39, s[56:59], s15 offen
    s_add_u32 s15, s15, 8064
    buffer_load_dwordx4 v[96:99], v39, s[56:59], s15 offen
    s_add_u32 s15, s15, 8064
    buffer_load_dwordx4 v[100:103], v39, s[56:59], s15 offen
    s_add_u32 s15, s15, 8064
    buffer_load_dwordx4 v[104:107], v39, s[56:59], s15 offen
    s_add_u32 s15, s15, 8064
    buffer_load_dwordx4 v[108:111], v39, s[56:59], s15 offen
    s_add_u32 s15, s15, 8064
    buffer_load_dwordx4 v[112:115], v39, s[56:59], s15 offen
    s_add_u32 s15, s15, 8064
    buffer_load_dwordx4 v[116:119], v39, s[56:59], s15 offen
    s_add_u32 s15, s15, 8064
    buffer_load_dwordx4 v[120:123], v39, s[56:59], s15 offen
    s_waitcnt lgkmcnt(0)
    s_barrier
    v_cmp_le_u32 vcc, 144, v0
    v_lshlrev_b32 v14, 2, v0
    v_add_u32 v15, 16128, v14
    s_nop 0
    v_cndmask_b32 v14, v14, v15, vcc
    v_cmp_gt_u32 vcc, 288, v0
    s_nop 1
    s_and_saveexec_b64 s[72:73], vcc
    s_cbranch_execz L_ffn_a
    ds_read_b32 v130, v14 offset:2560
    ds_read_b32 v131, v14 offset:3136
    ds_read_b32 v132, v14 offset:3712
    ds_read_b32 v133, v14 offset:4288
    ds_read_b32 v134, v14 offset:4864
    ds_read_b32 v135, v14 offset:5440
    ds_read_b32 v136, v14 offset:6016
    ds_read_b32 v137, v14 offset:6592
    ds_read_b32 v138, v14 offset:7168
    ds_read_b32 v139, v14 offset:7744
    ds_read_b32 v140, v14 offset:8320
    ds_read_b32 v141, v14 offset:8896
    ds_read_b32 v142, v14 offset:9472
    ds_read_b32 v143, v14 offset:10048
    ds_read_b32 v144, v14 offset:10624
    ds_read_b32 v145, v14 offset:11200
    ds_read_b32 v146, v14 offset:11776
    ds_read_b32 v147, v14 offset:12352
    ds_read_b32 v148, v14 offset:12928
    ds_read_b32 v149, v14 offset:13504
    ds_read_b32 v150, v14 offset:14080
    ds_read_b32 v151, v14 offset:14656
    ds_read_b32 v152, v14 offset:15232
    ds_read_b32 v153, v14 offset:15808
    ds_read_b32 v154, v14 offset:16384
    ds_read_b32 v155, v14 offset:16960
    ds_read_b32 v156, v14 offset:17536
    ds_read_b32 v157, v14 offset:18112
    s_waitcnt lgkmcnt(0)
    v_add_f32 v130, v130, v131
    v_add_f32 v130, v130, v132
    v_add_f32 v130, v130, v133
    v_add_f32 v130, v130, v134
    v_add_f32 v130, v130, v135
    v_add_f32 v130, v130, v136
    v_add_f32 v130, v130, v137
    v_add_f32 v130, v130, v138
    v_add_f32 v130, v130, v139
    v_add_f32 v130, v130, v140
    v_add_f32 v130, v130, v141
    v_add_f32 v130, v130, v142
    v_add_f32 v130, v130, v143
    v_add_f32 v130, v130, v144
    v_add_f32 v130, v130, v145
    v_add_f32 v130, v130, v146
    v_add_f32 v130, v130, v147
    v_add_f32 v130, v130, v148
    v_add_f32 v130, v130, v149
    v_add_f32 v130, v130, v150
    v_add_f32 v130, v130, v151
    v_add_f32 v130, v130, v152
    v_add_f32 v130, v130, v153
    v_add_f32 v130, v130, v154
    v_add_f32 v130, v130, v155
    v_add_f32 v130, v130, v156
    v_add_f32 v130, v130, v157
    v_cvt_pk_bf16_f32 v130, v130, v130
    v_and_b32 v130, 0xffff0000, v130
    v_lshlrev_b32 v14, 2, v0
    ds_write_b32 v14, v130 offset:36096
L_ffn_a:
    s_mov_b64 exec, s[72:73]
    s_waitcnt lgkmcnt(0)
    s_barrier
    v_cmp_gt_u32 vcc, 152, v0
    s_nop 1
    s_and_saveexec_b64 s[72:73], vcc
    s_cbranch_execz L_ffn_b
    v_lshlrev_b32 v14, 2, v0
    ds_read_b32 v15, v14 offset:36096
    ds_read_b32 v16, v14 offset:36672
    s_waitcnt lgkmcnt(0)
    v_mul_f32 v17, v15, v15
    v_mul_f32 v17, 0x3d372713, v17
    v_fma_f32 v17, v17, v15, v15
    v_mul_f32 v17, 0x40135761, v17
    v_exp_f32 v17, v17
    s_nop 0
    v_add_f32 v17, 1.0, v17
    v_rcp_f32 v17, v17
    s_nop 0
    v_sub_f32 v17, 1.0, v17
    v_mul_f32 v17, v15, v17
    v_cvt_pk_bf16_f32 v17, v17, v17
    v_and_b32 v17, 0xffff0000, v17
    v_mul_f32 v17, v17, v16
    v_cvt_pk_bf16_f32 v17, v17, v17
    v_and_b32 v17, 0xffff0000, v17
    v_cmp_gt_u32 vcc, 144, v0
    s_nop 1
    v_cndmask_b32 v17, 0, v17, vcc
    ds_write_b32 v14, v17 offset:37248
L_ffn_b:
    s_mov_b64 exec, s[72:73]
    s_waitcnt lgkmcnt(0)
    s_barrier
    s_lshl_b32 s9, s8, 3
    s_add_u32 s9, s9, 7
    s_mul_i32 s9, s9, 2304
    v_lshlrev_b32 v36, 2, v37
    v_add_u32 v36, 37248, v36
    ds_read_b32 v14, v36 offset:0
    ds_read_b32 v15, v36 offset:28
    ds_read_b32 v16, v36 offset:56
    ds_read_b32 v17, v36 offset:84
    ds_read_b32 v18, v36 offset:112
    ds_read_b32 v19, v36 offset:140
    ds_read_b32 v20, v36 offset:168
    ds_read_b32 v21, v36 offset:196
    ds_read_b32 v22, v36 offset:224
    ds_read_b32 v23, v36 offset:252
    ds_read_b32 v24, v36 offset:280
    ds_read_b32 v25, v36 offset:308
    ds_read_b32 v26, v36 offset:336
    ds_read_b32 v27, v36 offset:364
    ds_read_b32 v28, v36 offset:392
    ds_read_b32 v29, v36 offset:420
    ds_read_b32 v30, v36 offset:448
    ds_read_b32 v31, v36 offset:476
    ds_read_b32 v32, v36 offset:504
    ds_read_b32 v33, v36 offset:532
    ds_read_b32 v34, v36 offset:560
    v_mov_b32 v6, 0
    v_mov_b32 v7, 0
    v_mov_b32 v8, 0
    v_mov_b32 v9, 0
    v_mov_b32 v10, 0
    v_mov_b32 v11, 0
    v_mov_b32 v12, 0
    v_mov_b32 v13, 0
    s_waitcnt vmcnt(0) lgkmcnt(0)
    v_lshlrev_b32 v39, 16, v40
    v_and_b32 v40, 0xffff0000, v40
    v_fmac_f32 v6, v14, v39
    v_fmac_f32 v7, v14, v40
    v_lshlrev_b32 v39, 16, v41
    v_and_b32 v41, 0xffff0000, v41
    v_fmac_f32 v8, v14, v39
    v_fmac_f32 v9, v14, v41
    v_lshlrev_b32 v39, 16, v42
    v_and_b32 v42, 0xffff0000, v42
    v_fmac_f32 v10, v14, v39
    v_fmac_f32 v11, v14, v42
    v_lshlrev_b32 v39, 16, v43
    v_and_b32 v43, 0xffff0000, v43
    v_fmac_f32 v12, v14, v39
    v_fmac_f32 v13, v14, v43
    v_lshlrev_b32 v39, 16, v44
    v_and_b32 v44, 0xffff0000, v44
    v_fmac_f32 v6, v15, v39
    v_fmac_f32 v7, v15, v44
    v_lshlrev_b32 v39, 16, v45
    v_and_b32 v45, 0xffff0000, v45
    v_fmac_f32 v8, v15, v39
    v_fmac_f32 v9, v15, v45
    v_lshlrev_b32 v39, 16, v46
    v_and_b32 v46, 0xffff0000, v46
    v_fmac_f32 v10, v15, v39
    v_fmac_f32 v11, v15, v46
    v_lshlrev_b32 v39, 16, v47
    v_and_b32 v47, 0xffff0000, v47
    v_fmac_f32 v12, v15, v39
    v_fmac_f32 v13, v15, v47
    v_lshlrev_b32 v39, 16, v48
    v_and_b32 v48, 0xffff0000, v48
    v_fmac_f32 v6, v16, v39
    v_fmac_f32 v7, v16, v48
    v_lshlrev_b32 v39, 16, v49
    v_and_b32 v49, 0xffff0000, v49
    v_fmac_f32 v8, v16, v39
    v_fmac_f32 v9, v16, v49
    v_lshlrev_b32 v39, 16, v50
    v_and_b32 v50, 0xffff0000, v50
    v_fmac_f32 v10, v16, v39
    v_fmac_f32 v11, v16, v50
    v_lshlrev_b32 v39, 16, v51
    v_and_b32 v51, 0xffff0000, v51
    v_fmac_f32 v12, v16, v39
    v_fmac_f32 v13, v16, v51
    v_lshlrev_b32 v39, 16, v52
    v_and_b32 v52, 0xffff0000, v52
    v_fmac_f32 v6, v17, v39
    v_fmac_f32 v7, v17, v52
    v_lshlrev_b32 v39, 16, v53
    v_and_b32 v53, 0xffff0000, v53
    v_fmac_f32 v8, v17, v39
    v_fmac_f32 v9, v17, v53
    v_lshlrev_b32 v39, 16, v54
    v_and_b32 v54, 0xffff0000, v54
    v_fmac_f32 v10, v17, v39
    v_fmac_f32 v11, v17, v54
    v_lshlrev_b32 v39, 16, v55
    v_and_b32 v55, 0xffff0000, v55
    v_fmac_f32 v12, v17, v39
    v_fmac_f32 v13, v17, v55
    v_lshlrev_b32 v39, 16, v56
    v_and_b32 v56, 0xffff0000, v56
    v_fmac_f32 v6, v18, v39
    v_fmac_f32 v7, v18, v56
    v_lshlrev_b32 v39, 16, v57
    v_and_b32 v57, 0xffff0000, v57
    v_fmac_f32 v8, v18, v39
    v_fmac_f32 v9, v18, v57
    v_lshlrev_b32 v39, 16, v58
    v_and_b32 v58, 0xffff0000, v58
    v_fmac_f32 v10, v18, v39
    v_fmac_f32 v11, v18, v58
    v_lshlrev_b32 v39, 16, v59
    v_and_b32 v59, 0xffff0000, v59
    v_fmac_f32 v12, v18, v39
    v_fmac_f32 v13, v18, v59
    v_lshlrev_b32 v39, 16, v60
    v_and_b32 v60, 0xffff0000, v60
    v_fmac_f32 v6, v19, v39
    v_fmac_f32 v7, v19, v60
    v_lshlrev_b32 v39, 16, v61
    v_and_b32 v61, 0xffff0000, v61
    v_fmac_f32 v8, v19, v39
    v_fmac_f32 v9, v19, v61
    v_lshlrev_b32 v39, 16, v62
    v_and_b32 v62, 0xffff0000, v62
    v_fmac_f32 v10, v19, v39
    v_fmac_f32 v11, v19, v62
    v_lshlrev_b32 v39, 16, v63
    v_and_b32 v63, 0xffff0000, v63
    v_fmac_f32 v12, v19, v39
    v_fmac_f32 v13, v19, v63
    v_lshlrev_b32 v39, 16, v64
    v_and_b32 v64, 0xffff0000, v64
    v_fmac_f32 v6, v20, v39
    v_fmac_f32 v7, v20, v64
    v_lshlrev_b32 v39, 16, v65
    v_and_b32 v65, 0xffff0000, v65
    v_fmac_f32 v8, v20, v39
    v_fmac_f32 v9, v20, v65
    v_lshlrev_b32 v39, 16, v66
    v_and_b32 v66, 0xffff0000, v66
    v_fmac_f32 v10, v20, v39
    v_fmac_f32 v11, v20, v66
    v_lshlrev_b32 v39, 16, v67
    v_and_b32 v67, 0xffff0000, v67
    v_fmac_f32 v12, v20, v39
    v_fmac_f32 v13, v20, v67
    v_lshlrev_b32 v39, 16, v68
    v_and_b32 v68, 0xffff0000, v68
    v_fmac_f32 v6, v21, v39
    v_fmac_f32 v7, v21, v68
    v_lshlrev_b32 v39, 16, v69
    v_and_b32 v69, 0xffff0000, v69
    v_fmac_f32 v8, v21, v39
    v_fmac_f32 v9, v21, v69
    v_lshlrev_b32 v39, 16, v70
    v_and_b32 v70, 0xffff0000, v70
    v_fmac_f32 v10, v21, v39
    v_fmac_f32 v11, v21, v70
    v_lshlrev_b32 v39, 16, v71
    v_and_b32 v71, 0xffff0000, v71
    v_fmac_f32 v12, v21, v39
    v_fmac_f32 v13, v21, v71
    v_lshlrev_b32 v39, 16, v72
    v_and_b32 v72, 0xffff0000, v72
    v_fmac_f32 v6, v22, v39
    v_fmac_f32 v7, v22, v72
    v_lshlrev_b32 v39, 16, v73
    v_and_b32 v73, 0xffff0000, v73
    v_fmac_f32 v8, v22, v39
    v_fmac_f32 v9, v22, v73
    v_lshlrev_b32 v39, 16, v74
    v_and_b32 v74, 0xffff0000, v74
    v_fmac_f32 v10, v22, v39
    v_fmac_f32 v11, v22, v74
    v_lshlrev_b32 v39, 16, v75
    v_and_b32 v75, 0xffff0000, v75
    v_fmac_f32 v12, v22, v39
    v_fmac_f32 v13, v22, v75
    v_lshlrev_b32 v39, 16, v76
    v_and_b32 v76, 0xffff0000, v76
    v_fmac_f32 v6, v23, v39
    v_fmac_f32 v7, v23, v76
    v_lshlrev_b32 v39, 16, v77
    v_and_b32 v77, 0xffff0000, v77
    v_fmac_f32 v8, v23, v39
    v_fmac_f32 v9, v23, v77
    v_lshlrev_b32 v39, 16, v78
    v_and_b32 v78, 0xffff0000, v78
    v_fmac_f32 v10, v23, v39
    v_fmac_f32 v11, v23, v78
    v_lshlrev_b32 v39, 16, v79
    v_and_b32 v79, 0xffff0000, v79
    v_fmac_f32 v12, v23, v39
    v_fmac_f32 v13, v23, v79
    v_lshlrev_b32 v39, 16, v80
    v_and_b32 v80, 0xffff0000, v80
    v_fmac_f32 v6, v24, v39
    v_fmac_f32 v7, v24, v80
    v_lshlrev_b32 v39, 16, v81
    v_and_b32 v81, 0xffff0000, v81
    v_fmac_f32 v8, v24, v39
    v_fmac_f32 v9, v24, v81
    v_lshlrev_b32 v39, 16, v82
    v_and_b32 v82, 0xffff0000, v82
    v_fmac_f32 v10, v24, v39
    v_fmac_f32 v11, v24, v82
    v_lshlrev_b32 v39, 16, v83
    v_and_b32 v83, 0xffff0000, v83
    v_fmac_f32 v12, v24, v39
    v_fmac_f32 v13, v24, v83
    v_lshlrev_b32 v39, 16, v84
    v_and_b32 v84, 0xffff0000, v84
    v_fmac_f32 v6, v25, v39
    v_fmac_f32 v7, v25, v84
    v_lshlrev_b32 v39, 16, v85
    v_and_b32 v85, 0xffff0000, v85
    v_fmac_f32 v8, v25, v39
    v_fmac_f32 v9, v25, v85
    v_lshlrev_b32 v39, 16, v86
    v_and_b32 v86, 0xffff0000, v86
    v_fmac_f32 v10, v25, v39
    v_fmac_f32 v11, v25, v86
    v_lshlrev_b32 v39, 16, v87
    v_and_b32 v87, 0xffff0000, v87
    v_fmac_f32 v12, v25, v39
    v_fmac_f32 v13, v25, v87
    v_lshlrev_b32 v39, 16, v88
    v_and_b32 v88, 0xffff0000, v88
    v_fmac_f32 v6, v26, v39
    v_fmac_f32 v7, v26, v88
    v_lshlrev_b32 v39, 16, v89
    v_and_b32 v89, 0xffff0000, v89
    v_fmac_f32 v8, v26, v39
    v_fmac_f32 v9, v26, v89
    v_lshlrev_b32 v39, 16, v90
    v_and_b32 v90, 0xffff0000, v90
    v_fmac_f32 v10, v26, v39
    v_fmac_f32 v11, v26, v90
    v_lshlrev_b32 v39, 16, v91
    v_and_b32 v91, 0xffff0000, v91
    v_fmac_f32 v12, v26, v39
    v_fmac_f32 v13, v26, v91
    v_lshlrev_b32 v39, 16, v92
    v_and_b32 v92, 0xffff0000, v92
    v_fmac_f32 v6, v27, v39
    v_fmac_f32 v7, v27, v92
    v_lshlrev_b32 v39, 16, v93
    v_and_b32 v93, 0xffff0000, v93
    v_fmac_f32 v8, v27, v39
    v_fmac_f32 v9, v27, v93
    v_lshlrev_b32 v39, 16, v94
    v_and_b32 v94, 0xffff0000, v94
    v_fmac_f32 v10, v27, v39
    v_fmac_f32 v11, v27, v94
    v_lshlrev_b32 v39, 16, v95
    v_and_b32 v95, 0xffff0000, v95
    v_fmac_f32 v12, v27, v39
    v_fmac_f32 v13, v27, v95
    v_lshlrev_b32 v39, 16, v96
    v_and_b32 v96, 0xffff0000, v96
    v_fmac_f32 v6, v28, v39
    v_fmac_f32 v7, v28, v96
    v_lshlrev_b32 v39, 16, v97
    v_and_b32 v97, 0xffff0000, v97
    v_fmac_f32 v8, v28, v39
    v_fmac_f32 v9, v28, v97
    v_lshlrev_b32 v39, 16, v98
    v_and_b32 v98, 0xffff0000, v98
    v_fmac_f32 v10, v28, v39
    v_fmac_f32 v11, v28, v98
    v_lshlrev_b32 v39, 16, v99
    v_and_b32 v99, 0xffff0000, v99
    v_fmac_f32 v12, v28, v39
    v_fmac_f32 v13, v28, v99
    v_lshlrev_b32 v39, 16, v100
    v_and_b32 v100, 0xffff0000, v100
    v_fmac_f32 v6, v29, v39
    v_fmac_f32 v7, v29, v100
    v_lshlrev_b32 v39, 16, v101
    v_and_b32 v101, 0xffff0000, v101
    v_fmac_f32 v8, v29, v39
    v_fmac_f32 v9, v29, v101
    v_lshlrev_b32 v39, 16, v102
    v_and_b32 v102, 0xffff0000, v102
    v_fmac_f32 v10, v29, v39
    v_fmac_f32 v11, v29, v102
    v_lshlrev_b32 v39, 16, v103
    v_and_b32 v103, 0xffff0000, v103
    v_fmac_f32 v12, v29, v39
    v_fmac_f32 v13, v29, v103
    v_lshlrev_b32 v39, 16, v104
    v_and_b32 v104, 0xffff0000, v104
    v_fmac_f32 v6, v30, v39
    v_fmac_f32 v7, v30, v104
    v_lshlrev_b32 v39, 16, v105
    v_and_b32 v105, 0xffff0000, v105
    v_fmac_f32 v8, v30, v39
    v_fmac_f32 v9, v30, v105
    v_lshlrev_b32 v39, 16, v106
    v_and_b32 v106, 0xffff0000, v106
    v_fmac_f32 v10, v30, v39
    v_fmac_f32 v11, v30, v106
    v_lshlrev_b32 v39, 16, v107
    v_and_b32 v107, 0xffff0000, v107
    v_fmac_f32 v12, v30, v39
    v_fmac_f32 v13, v30, v107
    v_lshlrev_b32 v39, 16, v108
    v_and_b32 v108, 0xffff0000, v108
    v_fmac_f32 v6, v31, v39
    v_fmac_f32 v7, v31, v108
    v_lshlrev_b32 v39, 16, v109
    v_and_b32 v109, 0xffff0000, v109
    v_fmac_f32 v8, v31, v39
    v_fmac_f32 v9, v31, v109
    v_lshlrev_b32 v39, 16, v110
    v_and_b32 v110, 0xffff0000, v110
    v_fmac_f32 v10, v31, v39
    v_fmac_f32 v11, v31, v110
    v_lshlrev_b32 v39, 16, v111
    v_and_b32 v111, 0xffff0000, v111
    v_fmac_f32 v12, v31, v39
    v_fmac_f32 v13, v31, v111
    v_lshlrev_b32 v39, 16, v112
    v_and_b32 v112, 0xffff0000, v112
    v_fmac_f32 v6, v32, v39
    v_fmac_f32 v7, v32, v112
    v_lshlrev_b32 v39, 16, v113
    v_and_b32 v113, 0xffff0000, v113
    v_fmac_f32 v8, v32, v39
    v_fmac_f32 v9, v32, v113
    v_lshlrev_b32 v39, 16, v114
    v_and_b32 v114, 0xffff0000, v114
    v_fmac_f32 v10, v32, v39
    v_fmac_f32 v11, v32, v114
    v_lshlrev_b32 v39, 16, v115
    v_and_b32 v115, 0xffff0000, v115
    v_fmac_f32 v12, v32, v39
    v_fmac_f32 v13, v32, v115
    v_lshlrev_b32 v39, 16, v116
    v_and_b32 v116, 0xffff0000, v116
    v_fmac_f32 v6, v33, v39
    v_fmac_f32 v7, v33, v116
    v_lshlrev_b32 v39, 16, v117
    v_and_b32 v117, 0xffff0000, v117
    v_fmac_f32 v8, v33, v39
    v_fmac_f32 v9, v33, v117
    v_lshlrev_b32 v39, 16, v118
    v_and_b32 v118, 0xffff0000, v118
    v_fmac_f32 v10, v33, v39
    v_fmac_f32 v11, v33, v118
    v_lshlrev_b32 v39, 16, v119
    v_and_b32 v119, 0xffff0000, v119
    v_fmac_f32 v12, v33, v39
    v_fmac_f32 v13, v33, v119
    v_lshlrev_b32 v39, 16, v120
    v_and_b32 v120, 0xffff0000, v120
    v_fmac_f32 v6, v34, v39
    v_fmac_f32 v7, v34, v120
    v_lshlrev_b32 v39, 16, v121
    v_and_b32 v121, 0xffff0000, v121
    v_fmac_f32 v8, v34, v39
    v_fmac_f32 v9, v34, v121
    v_lshlrev_b32 v39, 16, v122
    v_and_b32 v122, 0xffff0000, v122
    v_fmac_f32 v10, v34, v39
    v_fmac_f32 v11, v34, v122
    v_lshlrev_b32 v39, 16, v123
    v_and_b32 v123, 0xffff0000, v123
    v_fmac_f32 v12, v34, v39
    v_fmac_f32 v13, v34, v123
    v_mul_u32_u24 v39, 2304, v37
    v_lshl_add_u32 v39, v38, 5, v39
    ds_write_b128 v39, v[6:9] offset:2560
    ds_write_b128 v39, v[10:13] offset:2576
    s_waitcnt lgkmcnt(0)
    s_barrier
    v_cmp_gt_u32 vcc, 144, v0
    s_nop 1
    s_and_saveexec_b64 s[72:73], vcc
    s_cbranch_execz L_done
    v_lshlrev_b32 v39, 4, v0
    ds_read_b128 v[40:43], v39 offset:2560
    ds_read_b128 v[44:47], v39 offset:4864
    ds_read_b128 v[48:51], v39 offset:7168
    ds_read_b128 v[52:55], v39 offset:9472
    ds_read_b128 v[56:59], v39 offset:11776
    ds_read_b128 v[60:63], v39 offset:14080
    ds_read_b128 v[64:67], v39 offset:16384
    s_waitcnt lgkmcnt(0)
    v_add_f32 v40, v40, v44
    v_add_f32 v41, v41, v45
    v_add_f32 v42, v42, v46
    v_add_f32 v43, v43, v47
    v_add_f32 v40, v40, v48
    v_add_f32 v41, v41, v49
    v_add_f32 v42, v42, v50
    v_add_f32 v43, v43, v51
    v_add_f32 v40, v40, v52
    v_add_f32 v41, v41, v53
    v_add_f32 v42, v42, v54
    v_add_f32 v43, v43, v55
    v_add_f32 v40, v40, v56
    v_add_f32 v41, v41, v57
    v_add_f32 v42, v42, v58
    v_add_f32 v43, v43, v59
    v_add_f32 v40, v40, v60
    v_add_f32 v41, v41, v61
    v_add_f32 v42, v42, v62
    v_add_f32 v43, v43, v63
    v_add_f32 v40, v40, v64
    v_add_f32 v41, v41, v65
    v_add_f32 v42, v42, v66
    v_add_f32 v43, v43, v67
    buffer_store_dwordx4 v[40:43], v39, s[64:67], s9 offen
L_done:
L_exit:
    s_endpgm
.globl fin_kernel
.p2align 8
.type fin_kernel,@function
fin_kernel:
    s_cmp_ge_u32 s2, 36
    s_cbranch_scc1 L_fdone
    s_load_dwordx2 s[4:5], s[0:1], 0
    s_load_dwordx2 s[6:7], s[0:1], 72
    s_load_dwordx2 s[8:9], s[0:1], 88
    s_mov_b32 s30, 0x3fb8aa3b
    v_mul_u32_u24 v1, 2304, v0
    v_lshlrev_b32 v2, 3, v0
    v_lshlrev_b32 v3, 1, v0
    s_lshl_b32 s3, s2, 6
    s_lshl_b32 s28, s2, 5
    s_waitcnt lgkmcnt(0)
    s_mov_b32 s12, s8
    s_and_b32 s13, s9, 0xffff
    s_mov_b32 s14, 0x100000
    s_mov_b32 s15, 0x00020000
    s_mov_b32 s16, s4
    s_and_b32 s17, s5, 0xffff
    s_movk_i32 s18, 1152
    s_mov_b32 s19, 0x00020000
    s_mov_b32 s20, s6
    s_and_b32 s21, s7, 0xffff
    s_movk_i32 s22, 1152
    s_mov_b32 s23, 0x00020000
    s_mov_b32 s24, 589824
    buffer_load_dwordx2 v[4:5], v2, s[12:15], s24 offen
    buffer_load_dwordx4 v[8:11], v1, s[12:15], s3 offen offset:0
    buffer_load_dwordx4 v[12:15], v1, s[12:15], s3 offen offset:16
    buffer_load_dwordx4 v[16:19], v1, s[12:15], s3 offen offset:32
    buffer_load_dwordx4 v[20:23], v1, s[12:15], s3 offen offset:48
    buffer_load_ushort v6, v3, s[16:19], s28 offen
    v_and_b32 v7, 7, v0
    v_cmp_eq_u32 vcc, 7, v7
    v_mov_b32 v24, 0xff800000
    s_waitcnt vmcnt(5)
    v_cndmask_b32 v4, v4, v24, vcc
    v_mov_b32 v25, 0
    v_cndmask_b32 v5, v5, v25, vcc
    v_mov_b32 v26, v4
    s_nop 1
    v_max_f32_dpp v26, v26, v26 quad_perm:[1,0,3,2] row_mask:0xf bank_mask:0xf
    s_nop 1
    v_max_f32_dpp v26, v26, v26 quad_perm:[2,3,0,1] row_mask:0xf bank_mask:0xf
    s_nop 1
    v_max_f32_dpp v26, v26, v26 row_half_mirror row_mask:0xf bank_mask:0xf
    v_sub_f32 v27, v4, v26
    v_mul_f32 v27, s30, v27
    v_exp_f32 v27, v27
    s_nop 0
    v_mul_f32 v28, v27, v5
    s_nop 1
    v_add_f32_dpp v28, v28, v28 quad_perm:[1,0,3,2] row_mask:0xf bank_mask:0xf
    s_nop 1
    v_add_f32_dpp v28, v28, v28 quad_perm:[2,3,0,1] row_mask:0xf bank_mask:0xf
    s_nop 1
    v_add_f32_dpp v28, v28, v28 row_half_mirror row_mask:0xf bank_mask:0xf
    v_rcp_f32 v29, v28
    s_nop 0
    v_fma_f32 v30, -v28, v29, 1.0
    v_fma_f32 v29, v30, v29, v29
    v_mul_f32 v27, v27, v29
    v_mov_b32 v25, 1.0
    v_cndmask_b32 v27, v27, v25, vcc
    s_waitcnt vmcnt(1)
    v_mul_f32 v8, v8, v27
    v_mul_f32 v9, v9, v27
    v_mul_f32 v10, v10, v27
    v_mul_f32 v11, v11, v27
    v_mul_f32 v12, v12, v27
    v_mul_f32 v13, v13, v27
    v_mul_f32 v14, v14, v27
    v_mul_f32 v15, v15, v27
    v_mul_f32 v16, v16, v27
    v_mul_f32 v17, v17, v27
    v_mul_f32 v18, v18, v27
    v_mul_f32 v19, v19, v27
    v_mul_f32 v20, v20, v27
    v_mul_f32 v21, v21, v27
    v_mul_f32 v22, v22, v27
    v_mul_f32 v23, v23, v27
    v_add_f32_dpp v8, v8, v8 row_ror:8 row_mask:0xf bank_mask:0xf
    v_add_f32_dpp v9, v9, v9 row_ror:8 row_mask:0xf bank_mask:0xf
    v_add_f32_dpp v10, v10, v10 row_ror:8 row_mask:0xf bank_mask:0xf
    v_add_f32_dpp v11, v11, v11 row_ror:8 row_mask:0xf bank_mask:0xf
    v_add_f32_dpp v12, v12, v12 row_ror:8 row_mask:0xf bank_mask:0xf
    v_add_f32_dpp v13, v13, v13 row_ror:8 row_mask:0xf bank_mask:0xf
    v_add_f32_dpp v14, v14, v14 row_ror:8 row_mask:0xf bank_mask:0xf
    v_add_f32_dpp v15, v15, v15 row_ror:8 row_mask:0xf bank_mask:0xf
    v_add_f32_dpp v16, v16, v16 row_ror:8 row_mask:0xf bank_mask:0xf
    v_add_f32_dpp v17, v17, v17 row_ror:8 row_mask:0xf bank_mask:0xf
    v_add_f32_dpp v18, v18, v18 row_ror:8 row_mask:0xf bank_mask:0xf
    v_add_f32_dpp v19, v19, v19 row_ror:8 row_mask:0xf bank_mask:0xf
    v_add_f32_dpp v20, v20, v20 row_ror:8 row_mask:0xf bank_mask:0xf
    v_add_f32_dpp v21, v21, v21 row_ror:8 row_mask:0xf bank_mask:0xf
    v_add_f32_dpp v22, v22, v22 row_ror:8 row_mask:0xf bank_mask:0xf
    v_add_f32_dpp v23, v23, v23 row_ror:8 row_mask:0xf bank_mask:0xf
    s_nop 1
    v_mov_b32 v31, v8
    s_nop 1
    v_permlane16_swap_b32 v8, v31
    s_nop 1
    v_add_f32 v8, v8, v31
    v_mov_b32 v31, v8
    s_nop 1
    v_permlane32_swap_b32 v8, v31
    s_nop 1
    v_add_f32 v8, v8, v31
    v_mov_b32 v31, v9
    s_nop 1
    v_permlane16_swap_b32 v9, v31
    s_nop 1
    v_add_f32 v9, v9, v31
    v_mov_b32 v31, v9
    s_nop 1
    v_permlane32_swap_b32 v9, v31
    s_nop 1
    v_add_f32 v9, v9, v31
    v_mov_b32 v31, v10
    s_nop 1
    v_permlane16_swap_b32 v10, v31
    s_nop 1
    v_add_f32 v10, v10, v31
    v_mov_b32 v31, v10
    s_nop 1
    v_permlane32_swap_b32 v10, v31
    s_nop 1
    v_add_f32 v10, v10, v31
    v_mov_b32 v31, v11
    s_nop 1
    v_permlane16_swap_b32 v11, v31
    s_nop 1
    v_add_f32 v11, v11, v31
    v_mov_b32 v31, v11
    s_nop 1
    v_permlane32_swap_b32 v11, v31
    s_nop 1
    v_add_f32 v11, v11, v31
    v_mov_b32 v31, v12
    s_nop 1
    v_permlane16_swap_b32 v12, v31
    s_nop 1
    v_add_f32 v12, v12, v31
    v_mov_b32 v31, v12
    s_nop 1
    v_permlane32_swap_b32 v12, v31
    s_nop 1
    v_add_f32 v12, v12, v31
    v_mov_b32 v31, v13
    s_nop 1
    v_permlane16_swap_b32 v13, v31
    s_nop 1
    v_add_f32 v13, v13, v31
    v_mov_b32 v31, v13
    s_nop 1
    v_permlane32_swap_b32 v13, v31
    s_nop 1
    v_add_f32 v13, v13, v31
    v_mov_b32 v31, v14
    s_nop 1
    v_permlane16_swap_b32 v14, v31
    s_nop 1
    v_add_f32 v14, v14, v31
    v_mov_b32 v31, v14
    s_nop 1
    v_permlane32_swap_b32 v14, v31
    s_nop 1
    v_add_f32 v14, v14, v31
    v_mov_b32 v31, v15
    s_nop 1
    v_permlane16_swap_b32 v15, v31
    s_nop 1
    v_add_f32 v15, v15, v31
    v_mov_b32 v31, v15
    s_nop 1
    v_permlane32_swap_b32 v15, v31
    s_nop 1
    v_add_f32 v15, v15, v31
    v_mov_b32 v31, v16
    s_nop 1
    v_permlane16_swap_b32 v16, v31
    s_nop 1
    v_add_f32 v16, v16, v31
    v_mov_b32 v31, v16
    s_nop 1
    v_permlane32_swap_b32 v16, v31
    s_nop 1
    v_add_f32 v16, v16, v31
    v_mov_b32 v31, v17
    s_nop 1
    v_permlane16_swap_b32 v17, v31
    s_nop 1
    v_add_f32 v17, v17, v31
    v_mov_b32 v31, v17
    s_nop 1
    v_permlane32_swap_b32 v17, v31
    s_nop 1
    v_add_f32 v17, v17, v31
    v_mov_b32 v31, v18
    s_nop 1
    v_permlane16_swap_b32 v18, v31
    s_nop 1
    v_add_f32 v18, v18, v31
    v_mov_b32 v31, v18
    s_nop 1
    v_permlane32_swap_b32 v18, v31
    s_nop 1
    v_add_f32 v18, v18, v31
    v_mov_b32 v31, v19
    s_nop 1
    v_permlane16_swap_b32 v19, v31
    s_nop 1
    v_add_f32 v19, v19, v31
    v_mov_b32 v31, v19
    s_nop 1
    v_permlane32_swap_b32 v19, v31
    s_nop 1
    v_add_f32 v19, v19, v31
    v_mov_b32 v31, v20
    s_nop 1
    v_permlane16_swap_b32 v20, v31
    s_nop 1
    v_add_f32 v20, v20, v31
    v_mov_b32 v31, v20
    s_nop 1
    v_permlane32_swap_b32 v20, v31
    s_nop 1
    v_add_f32 v20, v20, v31
    v_mov_b32 v31, v21
    s_nop 1
    v_permlane16_swap_b32 v21, v31
    s_nop 1
    v_add_f32 v21, v21, v31
    v_mov_b32 v31, v21
    s_nop 1
    v_permlane32_swap_b32 v21, v31
    s_nop 1
    v_add_f32 v21, v21, v31
    v_mov_b32 v31, v22
    s_nop 1
    v_permlane16_swap_b32 v22, v31
    s_nop 1
    v_add_f32 v22, v22, v31
    v_mov_b32 v31, v22
    s_nop 1
    v_permlane32_swap_b32 v22, v31
    s_nop 1
    v_add_f32 v22, v22, v31
    v_mov_b32 v31, v23
    s_nop 1
    v_permlane16_swap_b32 v23, v31
    s_nop 1
    v_add_f32 v23, v23, v31
    v_mov_b32 v31, v23
    s_nop 1
    v_permlane32_swap_b32 v23, v31
    s_nop 1
    v_add_f32 v23, v23, v31
    v_lshrrev_b32 v31, 6, v0
    v_lshlrev_b32 v31, 9, v31
    v_lshl_add_u32 v31, v7, 6, v31
    ds_write_b128 v31, v[8:11] offset:0
    ds_write_b128 v31, v[12:15] offset:16
    ds_write_b128 v31, v[16:19] offset:32
    ds_write_b128 v31, v[20:23] offset:48
    s_waitcnt lgkmcnt(0)
    s_barrier
    v_cmp_gt_u32 vcc, 16, v0
    s_nop 1
    s_and_saveexec_b64 s[26:27], vcc
    s_cbranch_execz L_fdone2
    v_lshlrev_b32 v31, 2, v0
    ds_read_b32 v32, v31 offset:0
    ds_read_b32 v33, v31 offset:64
    ds_read_b32 v34, v31 offset:128
    ds_read_b32 v35, v31 offset:192
    ds_read_b32 v36, v31 offset:256
    ds_read_b32 v37, v31 offset:320
    ds_read_b32 v38, v31 offset:384
    ds_read_b32 v39, v31 offset:448
    ds_read_b32 v40, v31 offset:512
    ds_read_b32 v41, v31 offset:576
    ds_read_b32 v42, v31 offset:640
    ds_read_b32 v43, v31 offset:704
    ds_read_b32 v44, v31 offset:768
    ds_read_b32 v45, v31 offset:832
    ds_read_b32 v46, v31 offset:896
    ds_read_b32 v47, v31 offset:960
    ds_read_b32 v48, v31 offset:1024
    ds_read_b32 v49, v31 offset:1088
    ds_read_b32 v50, v31 offset:1152
    ds_read_b32 v51, v31 offset:1216
    ds_read_b32 v52, v31 offset:1280
    ds_read_b32 v53, v31 offset:1344
    ds_read_b32 v54, v31 offset:1408
    ds_read_b32 v55, v31 offset:1472
    ds_read_b32 v56, v31 offset:1536
    ds_read_b32 v57, v31 offset:1600
    ds_read_b32 v58, v31 offset:1664
    ds_read_b32 v59, v31 offset:1728
    ds_read_b32 v60, v31 offset:1792
    ds_read_b32 v61, v31 offset:1856
    ds_read_b32 v62, v31 offset:1920
    ds_read_b32 v63, v31 offset:1984
    s_waitcnt lgkmcnt(0)
    v_add_f32 v32, v32, v33
    v_add_f32 v32, v32, v34
    v_add_f32 v32, v32, v35
    v_add_f32 v32, v32, v36
    v_add_f32 v32, v32, v37
    v_add_f32 v32, v32, v38
    v_add_f32 v32, v32, v40
    v_add_f32 v32, v32, v41
    v_add_f32 v32, v32, v42
    v_add_f32 v32, v32, v43
    v_add_f32 v32, v32, v44
    v_add_f32 v32, v32, v45
    v_add_f32 v32, v32, v46
    v_add_f32 v32, v32, v48
    v_add_f32 v32, v32, v49
    v_add_f32 v32, v32, v50
    v_add_f32 v32, v32, v51
    v_add_f32 v32, v32, v52
    v_add_f32 v32, v32, v53
    v_add_f32 v32, v32, v54
    v_add_f32 v32, v32, v56
    v_add_f32 v32, v32, v57
    v_add_f32 v32, v32, v58
    v_add_f32 v32, v32, v59
    v_add_f32 v32, v32, v60
    v_add_f32 v32, v32, v61
    v_add_f32 v32, v32, v62
    v_add_f32 v39, v39, v47
    v_add_f32 v39, v39, v55
    v_add_f32 v39, v39, v63
    v_cvt_pk_bf16_f32 v32, v32, v32
    v_and_b32 v32, 0xffff0000, v32
    v_cvt_pk_bf16_f32 v39, v39, v39
    v_and_b32 v39, 0xffff0000, v39
    s_waitcnt vmcnt(0)
    v_lshlrev_b32 v6, 16, v6
    v_add_f32 v6, v6, v32
    v_cvt_pk_bf16_f32 v6, v6, v6
    v_and_b32 v6, 0xffff0000, v6
    v_add_f32 v6, v6, v39
    v_cvt_pk_bf16_f32 v6, v6, v6
    buffer_store_short v6, v3, s[20:23], s28 offen
L_fdone2:
L_fdone:
    s_endpgm
.section .rodata,"a"
.p2align 6
.amdhsa_kernel parallel_sum__mha_block_cached__geglu_ffn__decode_kernel
  .amdhsa_next_free_vgpr 248
  .amdhsa_next_free_sgpr 100
  .amdhsa_accum_offset 248
  .amdhsa_group_segment_fixed_size 0
  .amdhsa_kernarg_size 96
  .amdhsa_user_sgpr_count 2
  .amdhsa_user_sgpr_kernarg_segment_ptr 1
  .amdhsa_system_sgpr_workgroup_id_x 1
.end_amdhsa_kernel
.p2align 6
.amdhsa_kernel fin_kernel
  .amdhsa_next_free_vgpr 64
  .amdhsa_next_free_sgpr 40
  .amdhsa_accum_offset 64
  .amdhsa_group_segment_fixed_size 0
  .amdhsa_kernarg_size 96
  .amdhsa_user_sgpr_count 2
  .amdhsa_user_sgpr_kernarg_segment_ptr 1
  .amdhsa_system_sgpr_workgroup_id_x 1
.end_amdhsa_kernel
```
